```python
import torch

def _softmax(x, axis=-1):
    return torch.softmax(x, dim=axis)
def _gelu(x):
    return torch.nn.functional.gelu(x, approximate="tanh")
def _silu(x):
    return torch.nn.functional.silu(x)
def _sigmoid(x):
    return torch.sigmoid(x)
def _layernorm(x, axis=-1, eps=1e-5):
    m = x.mean(dim=axis, keepdim=True)
    v = x.var(dim=axis, keepdim=True, unbiased=False)
    return (x - m) / torch.sqrt(v + eps)
def _scatter_add(tgt, idx, src, axis=0):
    return tgt.clone().index_add_(axis, idx, src)
def _segment_sum(src, seg, n):
    out = torch.zeros((n,) + src.shape[1:], dtype=src.dtype)
    return out.index_add_(0, seg, src)
def _pad(x, pw):
    flat = tuple(v for pair in reversed(pw) for v in pair)
    return torch.nn.functional.pad(x, flat)

kernel_name = 'standalone__edge_featured_mpnn_mpnn__graph'

def setup_inputs():

    _w = (lambda a: (lambda t: t.to(torch.bfloat16) if t.is_floating_point() else t)(torch.as_tensor(a)))
    N, deg, D, De = 25000, 16, 128, max(0, 1)
    E = N * deg
    H = 2 * D
    return {
        "x": _w((lambda *s: torch.randn(*s, dtype=torch.bfloat16) * 0.05)(N, D)),
        "e_attr": _w((lambda *s: torch.randn(*s, dtype=torch.bfloat16) * 1.6)(E, De)),
        "src": _w((lambda lo, hi, *s: torch.randint(lo, hi, s))(0, N, E).to(torch.int64)),
        "dst": _w((lambda lo, hi, *s: torch.randint(lo, hi, s))(0, N, E).to(torch.int64)),
        "w1": _w((lambda *s: torch.randn(*s, dtype=torch.bfloat16) * 1.6)(2 * D + De, H) * (1.0 / (2 * D + De) ** 0.5)),
        "b1": _w((lambda *s: torch.randn(*s, dtype=torch.bfloat16) * 1.6)(H) * 0.01),
        "w2": _w((lambda *s: torch.randn(*s, dtype=torch.bfloat16) * 0.05)(H, D) * (1.0 / H ** 0.5)),
        "b2": _w((lambda *s: torch.randn(*s, dtype=torch.bfloat16) * 0.05)(D) * 0.01),
    }

def reference(x, e_attr, src, dst, w1, b1, w2, b2):
    N, D = x.shape
    h_src = x[src]
    h_dst = x[dst]
    m_in = torch.concatenate([h_src, h_dst, e_attr], axis=-1)
    h = _silu(m_in @ w1 + b1)
    msg = h @ w2 + b2
    return _segment_sum(msg, dst, N)
```

```asm
; @launch grid=(256,1,1) block=(1024,1,1) lds=163840
.amdgcn_target "amdgcn-amd-amdhsa--gfx950"
.text
.globl standalone__edge_featured_mpnn_mpnn__graph_kernel
.p2align 8
.type standalone__edge_featured_mpnn_mpnn__graph_kernel,@function
standalone__edge_featured_mpnn_mpnn__graph_kernel:
    s_cmp_ge_u32 s2, 256
    s_cbranch_scc1 k2_end
    s_load_dwordx16 s[16:31], s[0:1], 0
    s_load_dwordx2 s[32:33], s[0:1], 80
    s_load_dwordx2 s[34:35], s[0:1], 64
    s_load_dwordx2 s[78:79], s[0:1], 72
    v_lshrrev_b32 v4, 6, v0
    v_and_b32 v1, 63, v0
    v_readfirstlane_b32 s3, v4
    v_lshlrev_b32 v5, 2, v0
    v_mov_b32 v15, 0
    ds_write_b32 v5, v15 offset:3072
    v_and_b32 v7, 0x301, v0
    v_cmp_eq_u32 vcc, 0, v7
    v_lshlrev_b32 v3, 4, v1
    v_lshlrev_b32 v2, 3, v1
    v_lshrrev_b32 v12, 4, v1
    v_mov_b32 v120, v0
    s_cmp_ge_u32 s3, 12
    s_cbranch_scc1 k2_noinit
    v_cndmask_b32 v6, 0, 63, vcc
    v_cndmask_b32 v7, 0, 64, vcc
    v_add_u32 v6, v6, v7
    ds_write_b32 v5, v6
k2_noinit:
    s_cmp_eq_u32 s2, 255
    s_cselect_b32 s4, 10, 98
    s_mov_b32 s42, 36864
    s_mov_b32 s43, 0x20000
    s_lshl_b32 s38, s4, 8
    s_mov_b32 s39, 0x20000
    s_mov_b32 s90, 131584
    s_mov_b32 s91, 0x20000
    s_mov_b32 s98, 0xbfb8aa3b
    s_mov_b32 s99, 0xbfb8aa3b
    s_cmp_ge_u32 s3, 8
    s_cbranch_scc1 k1_load
    s_lshr_b32 s7, s2, 4
    s_lshl_b32 s7, s7, 3
    s_and_b32 s5, s2, 7
    s_add_u32 s7, s7, s5
    s_bfe_u32 s8, s2, 0x10003
    s_mul_i32 s5, s7, 12512
    v_lshl_add_u32 v36, v0, 4, s5
    v_lshrrev_b32 v38, 1, v36
    v_add_u32 v37, 0x2000, v36
    v_add_u32 v39, 0x1000, v38
    s_movk_i32 s9, 270
    s_cmp_eq_u32 s7, 127
    s_cselect_b32 s9, 174, s9
    v_cmp_gt_u32 s[10:11], s9, v0
    s_waitcnt lgkmcnt(0)
    global_load_dwordx4 v[16:19], v36, s[22:23]
    s_mov_b64 exec, s[10:11]
    s_cbranch_execz k1_noe1
    global_load_dwordx4 v[20:23], v37, s[22:23]
    global_load_dwordx4 v[28:31], v37, s[20:21]
    global_load_dwordx2 v[34:35], v39, s[18:19]
k1_noe1:
    s_mov_b64 exec, -1
    global_load_dwordx4 v[24:27], v36, s[20:21]
    global_load_dwordx2 v[32:33], v38, s[18:19]
    s_barrier
    s_mul_i32 s5, s2, 36864
    s_add_u32 s5, s5, 13631488
    s_add_u32 s40, s32, s5
    s_addc_u32 s41, s33, 0
    s_mov_b32 s88, s24
    s_mov_b32 s89, s25
    s_mul_i32 s5, s2, 50176
    s_add_u32 s44, s32, s5
    s_addc_u32 s45, s33, 0
    s_lshl_b32 s46, s4, 9
    s_mov_b32 s47, 0x20000
    s_add_u32 s80, s32, 33751040
    s_addc_u32 s81, s33, 0
    s_movk_i32 s12, -98
    s_movk_i32 s13, 128
    s_mul_i32 s5, s8, 4718592
    s_lshl_b32 s6, s7, 8
    s_add_u32 s5, s5, s6
    s_add_u32 s5, s5, 13631488
    s_add_u32 s70, s32, s5
    s_addc_u32 s71, s33, 0
    v_lshrrev_b32 v13, 4, v120
    v_add_u32 v14, v13, v120
    v_and_b32 v14, 15, v14
    v_lshlrev_b32 v14, 4, v14
    v_lshl_add_u32 v4, v13, 8, v14
    v_and_b32 v14, 0xf0, v3
    v_lshlrev_b32 v5, 2, v13
    s_mov_b32 s5, 36864
    v_mad_u32_u24 v6, v13, s5, v14
    v_add_u32 v7, 1179648, v6
    v_add_u32 v8, 2359296, v6
    v_add_u32 v9, 3538944, v6
    v_and_b32 v11, 192, v14
    v_cmp_eq_u32 s[68:69], 0, v14
    v_lshrrev_b32 v122, 4, v1
    v_lshlrev_b32 v121, 1, v122
    v_xor_b32 v121, v121, v1
    v_and_b32 v121, 15, v121
    v_lshlrev_b32 v121, 4, v121
    v_lshl_or_b32 v121, v122, 9, v121
    v_xor_b32 v122, 0x1080, v121
    v_bfe_u32 v88, v1, 2, 1
    v_lshlrev_b32 v88, 5, v88
    v_bfe_u32 v14, v1, 3, 2
    v_lshl_add_u32 v88, v14, 3, v88
    v_and_b32 v14, 3, v1
    v_lshl_add_u32 v88, v14, 1, v88
    v_lshrrev_b32 v13, 5, v1
    v_lshl_add_u32 v88, v13, 8, v88
    s_and_b32 s64, s7, 7
    s_lshl_b32 s64, s64, 9
    s_and_b32 s5, s7, 8
    s_lshl_b32 s5, s5, 12
    s_add_u32 s64, s64, s5
    s_and_b32 s5, s7, 48
    s_lshl_b32 s5, s5, 2
    s_add_u32 s64, s64, s5
    s_add_u32 s64, s64, 4096
    v_add_u32 v88, s64, v88
    s_lshl_b32 s5, s7, 10
    s_add_u32 s5, s5, 33619968
    v_add_u32 v89, s5, v3
    s_and_b32 s5, s2, 0x88
    s_cselect_b32 s15, 0, s3
    s_lshl_b32 s9, s8, 7
    v_mov_b32 v14, 8
    s_mov_b64 s[64:65], 0
    s_cmp_eq_u64 s[10:11], 0
    s_cbranch_scc1 k1_part4
    s_waitcnt vmcnt(5)
    v_mul_u32_u24 v40, 42800, v16
    v_mul_u32_u24 v41, 42800, v17
    v_mul_u32_u24 v42, 42800, v18
    v_mul_u32_u24 v43, 42800, v19
    v_lshrrev_b32 v40, 22, v40
    v_lshrrev_b32 v41, 22, v41
    v_lshrrev_b32 v42, 22, v42
    v_lshrrev_b32 v43, 22, v43
    v_mad_i32_i24 v16, v40, s12, v16
    v_mad_i32_i24 v17, v41, s12, v17
    v_mad_i32_i24 v18, v42, s12, v18
    v_mad_i32_i24 v19, v43, s12, v19
    v_subrev_u32 v40, s9, v40
    v_subrev_u32 v41, s9, v41
    v_subrev_u32 v42, s9, v42
    v_subrev_u32 v43, s9, v43
    v_cmp_gt_u32 s[48:49], s13, v40
    v_lshlrev_b32 v72, 2, v40
    v_cmp_gt_u32 s[50:51], s13, v41
    v_lshlrev_b32 v73, 2, v41
    v_cmp_gt_u32 s[52:53], s13, v42
    v_lshlrev_b32 v74, 2, v42
    v_cmp_gt_u32 s[54:55], s13, v43
    v_lshlrev_b32 v75, 2, v43
    s_mov_b64 exec, s[48:49]
    ds_add_rtn_u32 v64, v72, v14 offset:2432
    s_mov_b64 exec, s[50:51]
    ds_add_rtn_u32 v65, v73, v14 offset:2432
    s_mov_b64 exec, s[52:53]
    ds_add_rtn_u32 v66, v74, v14 offset:2432
    s_mov_b64 exec, s[54:55]
    ds_add_rtn_u32 v67, v75, v14 offset:2432
    s_waitcnt vmcnt(4)
    s_mov_b64 exec, s[10:11]
    v_mul_u32_u24 v44, 42800, v20
    v_mul_u32_u24 v45, 42800, v21
    v_mul_u32_u24 v46, 42800, v22
    v_mul_u32_u24 v47, 42800, v23
    v_lshrrev_b32 v44, 22, v44
    v_lshrrev_b32 v45, 22, v45
    v_lshrrev_b32 v46, 22, v46
    v_lshrrev_b32 v47, 22, v47
    v_mad_i32_i24 v20, v44, s12, v20
    v_mad_i32_i24 v21, v45, s12, v21
    v_mad_i32_i24 v22, v46, s12, v22
    v_mad_i32_i24 v23, v47, s12, v23
    v_subrev_u32 v44, s9, v44
    v_subrev_u32 v45, s9, v45
    v_subrev_u32 v46, s9, v46
    v_subrev_u32 v47, s9, v47
    v_cmp_gt_u32 s[56:57], s13, v44
    v_lshlrev_b32 v76, 2, v44
    v_cmp_gt_u32 s[58:59], s13, v45
    v_lshlrev_b32 v77, 2, v45
    v_cmp_gt_u32 s[60:61], s13, v46
    v_lshlrev_b32 v78, 2, v46
    v_cmp_gt_u32 s[62:63], s13, v47
    v_lshlrev_b32 v79, 2, v47
    s_mov_b64 exec, s[56:57]
    ds_add_rtn_u32 v68, v76, v14 offset:2432
    s_mov_b64 exec, s[58:59]
    ds_add_rtn_u32 v69, v77, v14 offset:2432
    s_mov_b64 exec, s[60:61]
    ds_add_rtn_u32 v70, v78, v14 offset:2432
    s_mov_b64 exec, s[62:63]
    ds_add_rtn_u32 v71, v79, v14 offset:2432
    s_mov_b64 exec, -1
    v_lshlrev_b32 v80, 8, v40
    v_lshlrev_b32 v81, 8, v41
    v_lshlrev_b32 v82, 8, v42
    v_lshlrev_b32 v83, 8, v43
    v_lshlrev_b32 v84, 8, v44
    v_lshlrev_b32 v85, 8, v45
    v_lshlrev_b32 v86, 8, v46
    v_lshlrev_b32 v87, 8, v47
    s_waitcnt vmcnt(2)
    v_mul_u32_u24 v76, 335, v28
    v_lshlrev_b32 v56, 9, v28
    v_mul_u32_u24 v77, 335, v29
    v_lshlrev_b32 v58, 9, v29
    v_mul_u32_u24 v78, 335, v30
    v_lshlrev_b32 v60, 9, v30
    v_mul_u32_u24 v79, 335, v31
    v_lshlrev_b32 v62, 9, v31
    v_lshrrev_b32 v76, 20, v76
    v_lshlrev_b32 v28, 16, v34
    v_lshrrev_b32 v77, 20, v77
    v_and_b32 v29, 0xffff0000, v34
    v_lshrrev_b32 v78, 20, v78
    v_lshlrev_b32 v30, 16, v35
    v_lshrrev_b32 v79, 20, v79
    v_and_b32 v31, 0xffff0000, v35
    v_lshl_add_u32 v76, v20, 3, v76
    v_lshl_add_u32 v77, v21, 3, v77
    v_lshl_add_u32 v78, v22, 3, v78
    v_lshl_add_u32 v79, v23, 3, v79
    v_lshl_or_b32 v57, v76, 2, v28
    v_lshl_or_b32 v59, v77, 2, v29
    v_lshl_or_b32 v61, v78, 2, v30
    v_lshl_or_b32 v63, v79, 2, v31
    v_lshl_add_u32 v76, v44, 4, 8
    v_lshl_add_u32 v77, v45, 4, 8
    v_lshl_add_u32 v78, v46, 4, 8
    v_lshl_add_u32 v79, v47, 4, 8
    s_waitcnt lgkmcnt(0)
    s_mov_b64 exec, s[56:57]
    v_cmp_le_u32 vcc, 248, v68
    v_add_u32_sdwa v84, v76, v68 dst_sel:BYTE_0 dst_unused:UNUSED_PRESERVE src0_sel:DWORD src1_sel:DWORD
    s_andn2_b64 exec, exec, vcc
    s_or_b64 s[64:65], s[64:65], vcc
    ds_write_b64 v84, v[56:57] offset:7168
    s_mov_b64 exec, s[58:59]
    v_cmp_le_u32 vcc, 248, v69
    v_add_u32_sdwa v85, v77, v69 dst_sel:BYTE_0 dst_unused:UNUSED_PRESERVE src0_sel:DWORD src1_sel:DWORD
    s_andn2_b64 exec, exec, vcc
    s_or_b64 s[64:65], s[64:65], vcc
    ds_write_b64 v85, v[58:59] offset:7168
    s_mov_b64 exec, s[60:61]
    v_cmp_le_u32 vcc, 248, v70
    v_add_u32_sdwa v86, v78, v70 dst_sel:BYTE_0 dst_unused:UNUSED_PRESERVE src0_sel:DWORD src1_sel:DWORD
    s_andn2_b64 exec, exec, vcc
    s_or_b64 s[64:65], s[64:65], vcc
    ds_write_b64 v86, v[60:61] offset:7168
    s_mov_b64 exec, s[62:63]
    v_cmp_le_u32 vcc, 248, v71
    v_add_u32_sdwa v87, v79, v71 dst_sel:BYTE_0 dst_unused:UNUSED_PRESERVE src0_sel:DWORD src1_sel:DWORD
    s_andn2_b64 exec, exec, vcc
    s_or_b64 s[64:65], s[64:65], vcc
    ds_write_b64 v87, v[62:63] offset:7168
    s_mov_b64 exec, -1
    s_waitcnt vmcnt(0)
    v_mul_u32_u24 v72, 335, v24
    v_lshlrev_b32 v48, 9, v24
    v_mul_u32_u24 v73, 335, v25
    v_lshlrev_b32 v50, 9, v25
    v_mul_u32_u24 v74, 335, v26
    v_lshlrev_b32 v52, 9, v26
    v_mul_u32_u24 v75, 335, v27
    v_lshlrev_b32 v54, 9, v27
    v_lshrrev_b32 v72, 20, v72
    v_lshlrev_b32 v24, 16, v32
    v_lshrrev_b32 v73, 20, v73
    v_and_b32 v25, 0xffff0000, v32
    v_lshrrev_b32 v74, 20, v74
    v_lshlrev_b32 v26, 16, v33
    v_lshrrev_b32 v75, 20, v75
    v_and_b32 v27, 0xffff0000, v33
    v_lshl_add_u32 v72, v16, 3, v72
    v_lshl_add_u32 v73, v17, 3, v73
    v_lshl_add_u32 v74, v18, 3, v74
    v_lshl_add_u32 v75, v19, 3, v75
    v_lshl_or_b32 v49, v72, 2, v24
    v_lshl_or_b32 v51, v73, 2, v25
    v_lshl_or_b32 v53, v74, 2, v26
    v_lshl_or_b32 v55, v75, 2, v27
    v_lshl_add_u32 v72, v40, 4, 8
    v_lshl_add_u32 v73, v41, 4, 8
    v_lshl_add_u32 v74, v42, 4, 8
    v_lshl_add_u32 v75, v43, 4, 8
    s_mov_b64 exec, s[48:49]
    v_cmp_le_u32 vcc, 248, v64
    v_add_u32_sdwa v80, v72, v64 dst_sel:BYTE_0 dst_unused:UNUSED_PRESERVE src0_sel:DWORD src1_sel:DWORD
    s_andn2_b64 exec, exec, vcc
    s_or_b64 s[64:65], s[64:65], vcc
    ds_write_b64 v80, v[48:49] offset:7168
    s_mov_b64 exec, s[50:51]
    v_cmp_le_u32 vcc, 248, v65
    v_add_u32_sdwa v81, v73, v65 dst_sel:BYTE_0 dst_unused:UNUSED_PRESERVE src0_sel:DWORD src1_sel:DWORD
    s_andn2_b64 exec, exec, vcc
    s_or_b64 s[64:65], s[64:65], vcc
    ds_write_b64 v81, v[50:51] offset:7168
    s_mov_b64 exec, s[52:53]
    v_cmp_le_u32 vcc, 248, v66
    v_add_u32_sdwa v82, v74, v66 dst_sel:BYTE_0 dst_unused:UNUSED_PRESERVE src0_sel:DWORD src1_sel:DWORD
    s_andn2_b64 exec, exec, vcc
    s_or_b64 s[64:65], s[64:65], vcc
    ds_write_b64 v82, v[52:53] offset:7168
    s_mov_b64 exec, s[54:55]
    v_cmp_le_u32 vcc, 248, v67
    v_add_u32_sdwa v83, v75, v67 dst_sel:BYTE_0 dst_unused:UNUSED_PRESERVE src0_sel:DWORD src1_sel:DWORD
    s_andn2_b64 exec, exec, vcc
    s_or_b64 s[64:65], s[64:65], vcc
    ds_write_b64 v83, v[54:55] offset:7168
    s_branch k1_part
k1_part4:
    s_cmp_lg_u32 s15, 7
    s_cbranch_scc1 k1_nofr
    global_load_ushort v90, v88, s[28:29] offset:-4096
    global_load_ushort v91, v88, s[28:29]
    v_add_u32 v88, 0x2000, v88
    global_load_ushort v92, v88, s[28:29] offset:-4096
    global_load_ushort v93, v88, s[28:29]
    v_add_u32 v88, 0x2000, v88
    global_load_ushort v94, v88, s[28:29] offset:-4096
    global_load_ushort v95, v88, s[28:29]
    v_add_u32 v88, 0x2000, v88
    global_load_ushort v96, v88, s[28:29] offset:-4096
    global_load_ushort v97, v88, s[28:29]
k1_nofr:
    s_mov_b64 s[56:57], 0
    s_mov_b64 s[58:59], 0
    s_mov_b64 s[60:61], 0
    s_mov_b64 s[62:63], 0
    s_waitcnt vmcnt(10)
    s_cbranch_scc0 k1_w1
    s_waitcnt vmcnt(2)
k1_w1:
    v_mul_u32_u24 v40, 42800, v16
    v_mul_u32_u24 v41, 42800, v17
    v_mul_u32_u24 v42, 42800, v18
    v_mul_u32_u24 v43, 42800, v19
    v_lshrrev_b32 v40, 22, v40
    v_lshrrev_b32 v41, 22, v41
    v_lshrrev_b32 v42, 22, v42
    v_lshrrev_b32 v43, 22, v43
    v_mad_i32_i24 v16, v40, s12, v16
    v_mad_i32_i24 v17, v41, s12, v17
    v_mad_i32_i24 v18, v42, s12, v18
    v_mad_i32_i24 v19, v43, s12, v19
    v_subrev_u32 v40, s9, v40
    v_subrev_u32 v41, s9, v41
    v_subrev_u32 v42, s9, v42
    v_subrev_u32 v43, s9, v43
    v_cmp_gt_u32 s[48:49], s13, v40
    v_lshlrev_b32 v72, 2, v40
    v_cmp_gt_u32 s[50:51], s13, v41
    v_lshlrev_b32 v73, 2, v41
    v_cmp_gt_u32 s[52:53], s13, v42
    v_lshlrev_b32 v74, 2, v42
    v_cmp_gt_u32 s[54:55], s13, v43
    v_lshlrev_b32 v75, 2, v43
    s_mov_b64 exec, s[48:49]
    ds_add_rtn_u32 v64, v72, v14 offset:2432
    s_mov_b64 exec, s[50:51]
    ds_add_rtn_u32 v65, v73, v14 offset:2432
    s_mov_b64 exec, s[52:53]
    ds_add_rtn_u32 v66, v74, v14 offset:2432
    s_mov_b64 exec, s[54:55]
    ds_add_rtn_u32 v67, v75, v14 offset:2432
    s_mov_b64 exec, -1
    v_lshlrev_b32 v80, 8, v40
    v_lshlrev_b32 v81, 8, v41
    v_lshlrev_b32 v82, 8, v42
    v_lshlrev_b32 v83, 8, v43
    s_waitcnt vmcnt(8)
    s_cbranch_scc0 k1_w2
    s_waitcnt vmcnt(0)
k1_w2:
    v_mul_u32_u24 v72, 335, v24
    v_lshlrev_b32 v48, 9, v24
    v_mul_u32_u24 v73, 335, v25
    v_lshlrev_b32 v50, 9, v25
    v_mul_u32_u24 v74, 335, v26
    v_lshlrev_b32 v52, 9, v26
    v_mul_u32_u24 v75, 335, v27
    v_lshlrev_b32 v54, 9, v27
    v_lshrrev_b32 v72, 20, v72
    v_lshlrev_b32 v24, 16, v32
    v_lshrrev_b32 v73, 20, v73
    v_and_b32 v25, 0xffff0000, v32
    v_lshrrev_b32 v74, 20, v74
    v_lshlrev_b32 v26, 16, v33
    v_lshrrev_b32 v75, 20, v75
    v_and_b32 v27, 0xffff0000, v33
    v_lshl_add_u32 v72, v16, 3, v72
    v_lshl_add_u32 v73, v17, 3, v73
    v_lshl_add_u32 v74, v18, 3, v74
    v_lshl_add_u32 v75, v19, 3, v75
    v_lshl_or_b32 v49, v72, 2, v24
    v_lshl_or_b32 v51, v73, 2, v25
    v_lshl_or_b32 v53, v74, 2, v26
    v_lshl_or_b32 v55, v75, 2, v27
    v_lshl_add_u32 v72, v40, 4, 8
    v_lshl_add_u32 v73, v41, 4, 8
    v_lshl_add_u32 v74, v42, 4, 8
    v_lshl_add_u32 v75, v43, 4, 8
    s_waitcnt lgkmcnt(0)
    s_mov_b64 exec, s[48:49]
    v_cmp_le_u32 vcc, 248, v64
    v_add_u32_sdwa v80, v72, v64 dst_sel:BYTE_0 dst_unused:UNUSED_PRESERVE src0_sel:DWORD src1_sel:DWORD
    s_andn2_b64 exec, exec, vcc
    s_or_b64 s[64:65], s[64:65], vcc
    ds_write_b64 v80, v[48:49] offset:7168
    s_mov_b64 exec, s[50:51]
    v_cmp_le_u32 vcc, 248, v65
    v_add_u32_sdwa v81, v73, v65 dst_sel:BYTE_0 dst_unused:UNUSED_PRESERVE src0_sel:DWORD src1_sel:DWORD
    s_andn2_b64 exec, exec, vcc
    s_or_b64 s[64:65], s[64:65], vcc
    ds_write_b64 v81, v[50:51] offset:7168
    s_mov_b64 exec, s[52:53]
    v_cmp_le_u32 vcc, 248, v66
    v_add_u32_sdwa v82, v74, v66 dst_sel:BYTE_0 dst_unused:UNUSED_PRESERVE src0_sel:DWORD src1_sel:DWORD
    s_andn2_b64 exec, exec, vcc
    s_or_b64 s[64:65], s[64:65], vcc
    ds_write_b64 v82, v[52:53] offset:7168
    s_mov_b64 exec, s[54:55]
    v_cmp_le_u32 vcc, 248, v67
    v_add_u32_sdwa v83, v75, v67 dst_sel:BYTE_0 dst_unused:UNUSED_PRESERVE src0_sel:DWORD src1_sel:DWORD
    s_andn2_b64 exec, exec, vcc
    s_or_b64 s[64:65], s[64:65], vcc
    ds_write_b64 v83, v[54:55] offset:7168
k1_part:
    s_cmp_eq_u64 s[64:65], 0
    s_cbranch_scc1 k1_staged
    s_lshl_b32 s5, s2, 15
    s_add_u32 s5, s5, 25165824
    s_add_u32 s66, s32, s5
    s_addc_u32 s67, s33, 0
    s_mov_b64 exec, s[48:49]
    v_cmp_le_u32 vcc, 248, v64
    s_and_b64 exec, exec, vcc
    s_cbranch_execz k1_ov0
    ds_add_rtn_u32 v72, v15, v14 offset:2944
    v_add_u32 v40, s9, v40
    v_or_b32 v48, v48, v40
    s_waitcnt lgkmcnt(0)
    global_store_dwordx2 v72, v[48:49], s[66:67] sc1
k1_ov0:
    s_mov_b64 exec, s[50:51]
    v_cmp_le_u32 vcc, 248, v65
    s_and_b64 exec, exec, vcc
    s_cbranch_execz k1_ov1
    ds_add_rtn_u32 v73, v15, v14 offset:2944
    v_add_u32 v41, s9, v41
    v_or_b32 v50, v50, v41
    s_waitcnt lgkmcnt(0)
    global_store_dwordx2 v73, v[50:51], s[66:67] sc1
k1_ov1:
    s_mov_b64 exec, s[52:53]
    v_cmp_le_u32 vcc, 248, v66
    s_and_b64 exec, exec, vcc
    s_cbranch_execz k1_ov2
    ds_add_rtn_u32 v74, v15, v14 offset:2944
    v_add_u32 v42, s9, v42
    v_or_b32 v52, v52, v42
    s_waitcnt lgkmcnt(0)
    global_store_dwordx2 v74, v[52:53], s[66:67] sc1
k1_ov2:
    s_mov_b64 exec, s[54:55]
    v_cmp_le_u32 vcc, 248, v67
    s_and_b64 exec, exec, vcc
    s_cbranch_execz k1_ov3
    ds_add_rtn_u32 v75, v15, v14 offset:2944
    v_add_u32 v43, s9, v43
    v_or_b32 v54, v54, v43
    s_waitcnt lgkmcnt(0)
    global_store_dwordx2 v75, v[54:55], s[66:67] sc1
k1_ov3:
    s_mov_b64 exec, s[56:57]
    v_cmp_le_u32 vcc, 248, v68
    s_and_b64 exec, exec, vcc
    s_cbranch_execz k1_ov4
    ds_add_rtn_u32 v76, v15, v14 offset:2944
    v_add_u32 v44, s9, v44
    v_or_b32 v56, v56, v44
    s_waitcnt lgkmcnt(0)
    global_store_dwordx2 v76, v[56:57], s[66:67] sc1
k1_ov4:
    s_mov_b64 exec, s[58:59]
    v_cmp_le_u32 vcc, 248, v69
    s_and_b64 exec, exec, vcc
    s_cbranch_execz k1_ov5
    ds_add_rtn_u32 v77, v15, v14 offset:2944
    v_add_u32 v45, s9, v45
    v_or_b32 v58, v58, v45
    s_waitcnt lgkmcnt(0)
    global_store_dwordx2 v77, v[58:59], s[66:67] sc1
k1_ov5:
    s_mov_b64 exec, s[60:61]
    v_cmp_le_u32 vcc, 248, v70
    s_and_b64 exec, exec, vcc
    s_cbranch_execz k1_ov6
    ds_add_rtn_u32 v78, v15, v14 offset:2944
    v_add_u32 v46, s9, v46
    v_or_b32 v60, v60, v46
    s_waitcnt lgkmcnt(0)
    global_store_dwordx2 v78, v[60:61], s[66:67] sc1
k1_ov6:
    s_mov_b64 exec, s[62:63]
    v_cmp_le_u32 vcc, 248, v71
    s_and_b64 exec, exec, vcc
    s_cbranch_execz k1_ov7
    ds_add_rtn_u32 v79, v15, v14 offset:2944
    v_add_u32 v47, s9, v47
    v_or_b32 v62, v62, v47
    s_waitcnt lgkmcnt(0)
    global_store_dwordx2 v79, v[62:63], s[66:67] sc1
k1_ov7:
k1_staged:
    s_mov_b64 exec, -1
    v_mov_b32 v13, 1
    s_mov_b64 exec, 1
    ds_add_u32 v15, v13 offset:2960
    s_mov_b64 exec, -1
    s_mov_b32 s77, 400000
k1_pst:
    ds_read_b32 v13, v15 offset:2960
    s_sub_u32 s77, s77, 1
    s_cbranch_scc1 k1_pst_ok
    s_waitcnt lgkmcnt(0)
    v_readfirstlane_b32 s5, v13
    s_and_b32 s5, s5, -1
    s_cmp_lg_u32 s5, 8
    s_cbranch_scc1 k1_pst
k1_pst_ok:
    ds_read_b32 v32, v5 offset:2432
    ds_read_b128 v[16:19], v4 offset:7168
    ds_read_b32 v33, v5 offset:2560
    ds_read_b128 v[20:23], v4 offset:15360
    ds_read_b32 v34, v5 offset:2688
    ds_read_b128 v[24:27], v4 offset:23552
    ds_read_b32 v35, v5 offset:2816
    ds_read_b128 v[28:31], v4 offset:31744
    ds_read_b32 v14, v15 offset:2944
    s_waitcnt lgkmcnt(7)
    v_cndmask_b32 v16, v16, v32, s[68:69]
    v_cmp_le_u32 vcc, v11, v32
    s_mov_b64 exec, vcc
    global_store_dwordx4 v6, v[16:19], s[70:71] sc1
    s_mov_b64 exec, -1
    s_waitcnt lgkmcnt(5)
    v_cndmask_b32 v20, v20, v33, s[68:69]
    v_cmp_le_u32 vcc, v11, v33
    s_mov_b64 exec, vcc
    global_store_dwordx4 v7, v[20:23], s[70:71] sc1
    s_mov_b64 exec, -1
    s_waitcnt lgkmcnt(3)
    v_cndmask_b32 v24, v24, v34, s[68:69]
    v_cmp_le_u32 vcc, v11, v34
    s_mov_b64 exec, vcc
    global_store_dwordx4 v8, v[24:27], s[70:71] sc1
    s_mov_b64 exec, -1
    s_waitcnt lgkmcnt(1)
    v_cndmask_b32 v28, v28, v35, s[68:69]
    v_cmp_le_u32 vcc, v11, v35
    s_mov_b64 exec, vcc
    global_store_dwordx4 v9, v[28:31], s[70:71] sc1
    s_mov_b64 exec, -1
    s_lshl_b32 s5, s2, 4
    s_add_u32 s5, s5, s3
    s_cmp_lg_u32 s5, 6
    s_cbranch_scc1 k1_noz
    v_lshlrev_b32 v13, 7, v1
    global_store_dword v13, v15, s[80:81] sc1
k1_noz:
    s_cmp_lg_u32 s3, 7
    s_cbranch_scc1 k1_nooc
    s_lshl_b32 s5, s2, 2
    s_add_u32 s5, s5, 33554432
    v_mov_b32 v13, s5
    s_mov_b64 exec, 1
    s_waitcnt lgkmcnt(0)
    global_store_dword v13, v14, s[32:33] sc1
    s_mov_b64 exec, -1
    s_cmp_lg_u32 s15, 7
    s_cbranch_scc1 k1_nooc
    s_waitcnt vmcnt(5)
    v_lshl_or_b32 v90, v91, 16, v90
    v_lshl_or_b32 v91, v93, 16, v92
    v_lshl_or_b32 v92, v95, 16, v94
    v_lshl_or_b32 v93, v97, 16, v96
    global_store_dwordx4 v89, v[90:93], s[32:33] sc1
k1_nooc:
    s_mov_b32 s44, s32
    s_mov_b32 s45, s33
    s_mov_b32 s46, 12800000
    s_mov_b32 s47, 0x20000
    s_mov_b32 s74, 0xffffff00
    s_mov_b32 s75, 0xffffff00
    s_mov_b32 s82, 0x21800000
    s_mov_b32 s83, 0x21800000
    s_lshl_b32 s6, s3, 12
    s_add_u32 s86, s6, 16384
    s_add_u32 s6, s6, 33619968
    s_add_u32 s84, s32, s6
    s_addc_u32 s85, s33, 0
    v_and_b32 v60, 1, v1
    v_cmp_eq_u32 vcc, 0, v60
    v_mov_b32 v61, 0x01000c0c
    v_mov_b32 v62, 0x0c0c0100
    v_cndmask_b32 v61, v61, v62, vcc
    v_and_b32 v60, 2, v1
    v_cmp_eq_u32 vcc, 0, v60
    v_mov_b32 v62, 0x0c0c0c0c
    v_mov_b32 v63, 0x3f80
    v_cndmask_b32 v10, v62, v61, vcc
    v_cndmask_b32 v11, v61, v62, vcc
    v_perm_b32 v4, v63, v63, v10
    v_perm_b32 v5, v63, v63, v11
    s_lshl_b32 s5, s3, 12
    v_add_u32 v56, s5, v3
    s_and_b32 s5, s2, 1
    s_lshl1_add_u32 s5, s8, s5
    s_lshl_b32 s5, s5, 6
    v_mov_b32 v57, s5
    v_lshlrev_b32 v58, 6, v1
    s_and_b32 s5, s3, 2
    s_lshl_b32 s5, s5, 6
    v_xor_b32 v122, s5, v121
    v_mov_b32 v13, 1
    v_mov_b32 v12, 0x1000
    s_mov_b64 exec, 1
    s_waitcnt vmcnt(0)
    ds_add_rtn_u32 v14, v15, v13 offset:2964
    s_waitcnt lgkmcnt(0)
    v_readfirstlane_b32 s66, v14
    s_cmp_lg_u32 s66, 7
    s_cbranch_scc1 k1_rnot
    global_atomic_add v57, v13, s[78:79] sc1
    s_branch k1_bl
k1_rnot:
    s_mov_b32 s77, 400000
k1_pb2:
    ds_read_b32 v14, v15 offset:2964
    s_sub_u32 s77, s77, 1
    s_cbranch_scc1 k1_pb2_ok
    s_waitcnt lgkmcnt(0)
    v_readfirstlane_b32 s5, v14
    s_and_b32 s5, s5, -1
    s_cmp_lg_u32 s5, 8
    s_cbranch_scc1 k1_pb2
k1_pb2_ok:
    s_sleep 2
k1_bl:
    s_mov_b64 exec, -1
    s_lshl_b32 s6, s3, 10
    s_lshl_b32 s5, s3, 11
    s_add_u32 s5, s5, 65536
    s_add_u32 m0, s6, 131072
    s_nop 0
    buffer_load_dwordx4 v122, s[88:91], s5 offen lds
    s_add_u32 m0, s6, 6912
    s_nop 0
    buffer_load_dwordx4 v122, s[88:91], s5 offen offset:256 lds
    s_add_u32 m0, s6, 139264
    s_add_u32 s5, s5, 16384
    buffer_load_dwordx4 v122, s[88:91], s5 offen lds
    s_add_u32 m0, s6, 15104
    s_nop 0
    buffer_load_dwordx4 v122, s[88:91], s5 offen offset:256 lds
    s_add_u32 m0, s6, 147456
    s_add_u32 s5, s5, 16384
    buffer_load_dwordx4 v122, s[88:91], s5 offen lds
    s_add_u32 m0, s6, 23296
    s_nop 0
    buffer_load_dwordx4 v122, s[88:91], s5 offen offset:256 lds
    s_add_u32 m0, s6, 155648
    s_add_u32 s5, s5, 16384
    buffer_load_dwordx4 v122, s[88:91], s5 offen lds
    s_add_u32 m0, s6, 31488
    s_nop 0
    buffer_load_dwordx4 v122, s[88:91], s5 offen offset:256 lds
    s_mov_b64 exec, 1
    s_cmp_lg_u32 s66, 7
    s_waitcnt vmcnt(0)
    ds_add_u32 v15, v12 offset:2956
    s_cbranch_scc1 k1_rwait
    s_sleep 8
    s_mov_b32 s77, 50000
    s_mov_b64 exec, 15
k1_gr:
    global_load_dword v14, v58, s[78:79] offset:0 sc1
    s_sub_u32 s77, s77, 1
    s_cbranch_scc1 k1_gr_ok
    s_waitcnt vmcnt(0)
    v_cmp_ne_u32 vcc, 64, v14
    s_cbranch_vccz k1_gr_ok
    s_sleep 4
    s_branch k1_gr
k1_gr_ok:
    s_mov_b64 exec, -1
    v_mov_b32 v12, 16777216
    s_mov_b64 exec, 1
    ds_add_u32 v15, v12 offset:2956
    s_mov_b64 exec, -1
    s_mov_b64 exec, 1
    ds_add_rtn_u32 v14, v15, v13 offset:2972
    s_and_b32 s5, s2, 15
    s_lshl_b32 s5, s5, 7
    v_mov_b32 v12, s5
    s_waitcnt lgkmcnt(0)
    v_cmp_eq_u32 vcc, 8, v14
    s_cbranch_vccz k1_rwait
    global_atomic_add v12, v13, s[80:81] sc1
k1_rwait:
    s_mov_b64 exec, -1
    s_mov_b32 s77, 400000
k1_prr:
    ds_read_b32 v13, v15 offset:2956
    s_sub_u32 s77, s77, 1
    s_cbranch_scc1 k1_prr_ok
    s_waitcnt lgkmcnt(0)
    v_readfirstlane_b32 s5, v13
    s_and_b32 s5, s5, 16777224
    s_cmp_lg_u32 s5, 16777224
    s_cbranch_scc1 k1_prr
k1_prr_ok:
    buffer_load_dwordx4 v[16:19], v56, s[40:43], 0 offen offset:0 sc1
    buffer_load_dwordx4 v[20:23], v56, s[40:43], 0 offen offset:1024 sc1
    buffer_load_dwordx4 v[24:27], v56, s[40:43], 0 offen offset:2048 sc1
    buffer_load_dwordx4 v[28:31], v56, s[40:43], 0 offen offset:3072 sc1
    v_and_b32 v60, 30, v1
    v_lshrrev_b32 v61, 5, v1
    v_lshl_add_u32 v60, v61, 8, v60
    v_and_b32 v61, 1, v1
    v_lshl_add_u32 v64, v61, 7, v60
    ds_read_u16 v60, v64 offset:1280
    ds_read_u16 v61, v64 offset:1312
    ds_read_u16 v62, v64 offset:1344
    ds_read_u16 v63, v64 offset:1376
    s_waitcnt lgkmcnt(0)
    v_lshlrev_b32 v60, 16, v60
    v_lshlrev_b32 v61, 16, v61
    v_lshlrev_b32 v62, 16, v62
    v_lshlrev_b32 v63, 16, v63
    v_pk_mul_f32 v[60:61], s[98:99], v[60:61]
    v_pk_mul_f32 v[62:63], s[98:99], v[62:63]
    v_cvt_pk_bf16_f32 v6, v60, v61
    v_cvt_pk_bf16_f32 v7, v62, v63
    v_and_b32 v100, 0xf0, v3
    v_add_u32 v101, 8, v100
    v_cmp_ne_u32 s[64:65], 0, v100
    v_mov_b32 v102, 4
    v_mov_b32 v109, 127
    s_waitcnt vmcnt(3)
    v_mov_b32_dpp v32, v16 row_newbcast:0 row_mask:0xf bank_mask:0xf
    v_and_b32 v44, 0xffff, v17
    v_and_b32 v45, 0xffff, v19
    v_cmp_le_u32 s[48:49], v100, v32
    v_cmp_le_u32 s[50:51], v101, v32
    s_and_b64 exec, s[48:49], s[64:65]
    s_mov_b64 s[48:49], exec
    ds_add_rtn_u32 v36, v44, v102 offset:3072
    s_mov_b64 exec, s[50:51]
    ds_add_rtn_u32 v37, v45, v102 offset:3072
    s_mov_b64 exec, -1
    s_waitcnt vmcnt(2)
    v_mov_b32_dpp v33, v20 row_newbcast:0 row_mask:0xf bank_mask:0xf
    v_and_b32 v46, 0xffff, v21
    v_and_b32 v47, 0xffff, v23
    v_cmp_le_u32 s[52:53], v100, v33
    v_cmp_le_u32 s[54:55], v101, v33
    s_and_b64 exec, s[52:53], s[64:65]
    s_mov_b64 s[52:53], exec
    ds_add_rtn_u32 v38, v46, v102 offset:3072
    s_mov_b64 exec, s[54:55]
    ds_add_rtn_u32 v39, v47, v102 offset:3072
    s_mov_b64 exec, -1
    s_waitcnt vmcnt(1)
    v_mov_b32_dpp v34, v24 row_newbcast:0 row_mask:0xf bank_mask:0xf
    v_and_b32 v48, 0xffff, v25
    v_and_b32 v49, 0xffff, v27
    v_cmp_le_u32 s[56:57], v100, v34
    v_cmp_le_u32 s[58:59], v101, v34
    s_and_b64 exec, s[56:57], s[64:65]
    s_mov_b64 s[56:57], exec
    ds_add_rtn_u32 v40, v48, v102 offset:3072
    s_mov_b64 exec, s[58:59]
    ds_add_rtn_u32 v41, v49, v102 offset:3072
    s_mov_b64 exec, -1
    s_waitcnt vmcnt(0)
    v_mov_b32_dpp v35, v28 row_newbcast:0 row_mask:0xf bank_mask:0xf
    v_and_b32 v50, 0xffff, v29
    v_and_b32 v51, 0xffff, v31
    v_cmp_le_u32 s[60:61], v100, v35
    v_cmp_le_u32 s[62:63], v101, v35
    s_and_b64 exec, s[60:61], s[64:65]
    s_mov_b64 s[60:61], exec
    ds_add_rtn_u32 v42, v50, v102 offset:3072
    s_mov_b64 exec, s[62:63]
    ds_add_rtn_u32 v43, v51, v102 offset:3072
    s_mov_b64 exec, -1
    v_max3_u32 v103, v32, v33, v34
    v_max_u32 v103, v103, v35
    v_cmp_lt_u32 vcc, 248, v103
    s_cbranch_vccz k2_noovf
    v_lshrrev_b32 v103, 4, v1
    s_lshl_b32 s5, s3, 4
    s_add_u32 s5, s5, 0
    v_add_u32 v103, s5, v103
    v_lshlrev_b32 v104, v103, 1
    v_lshrrev_b32 v103, 5, v103
    v_lshlrev_b32 v103, 2, v103
    v_cmp_lt_u32 vcc, 248, v32
    s_mov_b64 exec, vcc
    ds_or_b32 v103, v104 offset:2304
    s_mov_b64 exec, -1
    v_lshrrev_b32 v103, 4, v1
    s_lshl_b32 s5, s3, 4
    s_add_u32 s5, s5, 4
    v_add_u32 v103, s5, v103
    v_lshlrev_b32 v104, v103, 1
    v_lshrrev_b32 v103, 5, v103
    v_lshlrev_b32 v103, 2, v103
    v_cmp_lt_u32 vcc, 248, v33
    s_mov_b64 exec, vcc
    ds_or_b32 v103, v104 offset:2304
    s_mov_b64 exec, -1
    v_lshrrev_b32 v103, 4, v1
    s_lshl_b32 s5, s3, 4
    s_add_u32 s5, s5, 8
    v_add_u32 v103, s5, v103
    v_lshlrev_b32 v104, v103, 1
    v_lshrrev_b32 v103, 5, v103
    v_lshlrev_b32 v103, 2, v103
    v_cmp_lt_u32 vcc, 248, v34
    s_mov_b64 exec, vcc
    ds_or_b32 v103, v104 offset:2304
    s_mov_b64 exec, -1
    v_lshrrev_b32 v103, 4, v1
    s_lshl_b32 s5, s3, 4
    s_add_u32 s5, s5, 12
    v_add_u32 v103, s5, v103
    v_lshlrev_b32 v104, v103, 1
    v_lshrrev_b32 v103, 5, v103
    v_lshlrev_b32 v103, 2, v103
    v_cmp_lt_u32 vcc, 248, v35
    s_mov_b64 exec, vcc
    ds_or_b32 v103, v104 offset:2304
    s_mov_b64 exec, -1
k2_noovf:
    s_waitcnt lgkmcnt(0)
    s_barrier
    s_cmp_lg_u32 s3, 0
    s_cbranch_scc1 k2_noassign
    v_lshlrev_b32 v100, 5, v1
    ds_read_b128 v[64:67], v100 offset:3072
    ds_read_b128 v[68:71], v100 offset:3088
    ds_read_b128 v[72:75], v100 offset:5120
    ds_read_b128 v[76:79], v100 offset:5136
    v_add_u32 v101, 64, v1
    v_cmp_gt_u32 s[68:69], s4, v1
    v_cmp_gt_u32 s[70:71], s4, v101
    v_mov_b32 v102, 1
    v_lshlrev_b32 v103, 2, v1
    s_waitcnt lgkmcnt(2)
    v_add3_u32 v64, v64, v65, v66
    v_add3_u32 v67, v67, v68, v69
    v_add3_u32 v64, v64, v70, v71
    v_add_u32 v81, v64, v67
    v_min_u32 v84, 252, v81
    v_sub_u32 v84, 252, v84
    s_mov_b64 exec, s[68:69]
    ds_add_rtn_u32 v86, v84, v102 offset:1024
    s_mov_b64 exec, -1
    s_waitcnt lgkmcnt(1)
    v_add3_u32 v72, v72, v73, v74
    v_add3_u32 v75, v75, v76, v77
    v_add3_u32 v72, v72, v78, v79
    v_add_u32 v83, v72, v75
    v_min_u32 v85, 252, v83
    v_sub_u32 v85, 252, v85
    s_mov_b64 exec, s[70:71]
    ds_add_rtn_u32 v87, v85, v102 offset:1024
    s_mov_b64 exec, -1
    ds_read_b32 v88, v103 offset:1024
    v_mov_b32 v80, v1
    v_mov_b32 v82, v101
    v_lshrrev_b32 v64, 2, v81
    v_lshrrev_b32 v65, 2, v83
    ds_write_b32 v103, v64 offset:1280
    ds_write_b32 v103, v65 offset:1536
    s_waitcnt lgkmcnt(2)
    v_mov_b32 v89, v88
    s_nop 1
    v_add_u32_dpp v88, v88, v88 row_shr:1 row_mask:0xf bank_mask:0xf bound_ctrl:0
    s_nop 1
    v_add_u32_dpp v88, v88, v88 row_shr:2 row_mask:0xf bank_mask:0xf bound_ctrl:0
    s_nop 1
    v_add_u32_dpp v88, v88, v88 row_shr:4 row_mask:0xf bank_mask:0xf bound_ctrl:0
    s_nop 1
    v_add_u32_dpp v88, v88, v88 row_shr:8 row_mask:0xf bank_mask:0xf bound_ctrl:0
    s_nop 1
    v_add_u32_dpp v88, v88, v88 row_bcast:15 row_mask:0xa bank_mask:0xf
    s_nop 1
    v_add_u32_dpp v88, v88, v88 row_bcast:31 row_mask:0xc bank_mask:0xf
    v_sub_u32 v88, v88, v89
    ds_bpermute_b32 v66, v84, v88
    ds_bpermute_b32 v67, v85, v88
    s_waitcnt lgkmcnt(0)
    v_add_u32 v66, v66, v86
    v_bfe_i32 v68, v66, 4, 1
    v_xor_b32 v68, v68, v66
    v_and_b32 v68, 15, v68
    v_lshrrev_b32 v66, 4, v66
    v_lshl_add_u32 v66, v68, 3, v66
    v_lshlrev_b32 v68, 3, v66
    s_mov_b64 exec, s[68:69]
    ds_write_b64 v68, v[80:81] offset:0
    ds_write_b32 v103, v66 offset:1792
    s_mov_b64 exec, -1
    v_add_u32 v67, v67, v87
    v_bfe_i32 v69, v67, 4, 1
    v_xor_b32 v69, v69, v67
    v_and_b32 v69, 15, v69
    v_lshrrev_b32 v67, 4, v67
    v_lshl_add_u32 v67, v69, 3, v67
    v_lshlrev_b32 v69, 3, v67
    s_mov_b64 exec, s[70:71]
    ds_write_b64 v69, v[82:83] offset:0
    ds_write_b32 v103, v67 offset:2048
    s_mov_b64 exec, -1
    s_waitcnt lgkmcnt(0)
k2_noassign:
    s_barrier
    v_and_b32 v100, 7, v1
    s_lshl_b32 s5, s3, 6
    v_lshl_add_u32 v102, v100, 3, s5
    ds_read_b32 v101, v102 offset:0
    ds_read_b32 v102, v102 offset:512
    ds_read_b128 v[64:67], v3 offset:0
    v_lshrrev_b32 v104, 3, v1
    v_lshlrev_b32 v104, 2, v104
    v_lshlrev_b32 v100, 18, v100
    s_lshl_b32 s6, s3, 2
    s_add_u32 s68, s6, 31
    s_sub_u32 s6, s6, 1
    s_and_b32 s6, s6, 63
    s_waitcnt lgkmcnt(1)
    v_lshl_add_u32 v103, v101, 5, v104
    v_lshl_add_u32 v104, v102, 5, v104
    ds_read_b32 v105, v103 offset:3072
    ds_read_b32 v106, v104 offset:3072
    s_waitcnt lgkmcnt(2)
    v_add_u32 v108, v65, v67
    v_cmp_ne_u32 vcc, 127, v101
    v_cmp_ne_u32 s[70:71], v102, v109
    v_add_u32_dpp v108, v108, v108 row_shr:1 row_mask:0xf bank_mask:0xf bound_ctrl:0
    v_readlane_b32 s10, v101, 0
    s_nop 0
    v_add_u32_dpp v108, v108, v108 row_shr:2 row_mask:0xf bank_mask:0xf bound_ctrl:0
    v_readlane_b32 s11, v101, 1
    s_nop 0
    v_add_u32_dpp v108, v108, v108 row_shr:4 row_mask:0xf bank_mask:0xf bound_ctrl:0
    v_readlane_b32 s12, v101, 2
    s_nop 0
    v_add_u32_dpp v108, v108, v108 row_shr:8 row_mask:0xf bank_mask:0xf bound_ctrl:0
    v_readlane_b32 s13, v101, 3
    s_nop 0
    v_add_u32_dpp v108, v108, v108 row_bcast:15 row_mask:0xa bank_mask:0xf
    v_readlane_b32 s14, v101, 4
    s_nop 0
    v_add_u32_dpp v108, v108, v108 row_bcast:31 row_mask:0xc bank_mask:0xf
    v_readlane_b32 s15, v101, 5
    v_readlane_b32 s96, v101, 6
    v_readlane_b32 s8, v108, s6
    v_readlane_b32 s69, v108, s68
    s_waitcnt lgkmcnt(0)
    v_lshl_or_b32 v107, v106, 16, v105
    v_mov_b32 v105, v107
    s_cmp_eq_u32 s3, 0
    v_add_u32_dpp v107, v107, v107 row_shr:1 row_mask:0xf bank_mask:0xf bound_ctrl:0
    s_cselect_b32 s8, 0, s8
    s_lshl_b32 s5, s3, 7
    v_add_u32_dpp v107, v107, v107 row_shr:2 row_mask:0xf bank_mask:0xf bound_ctrl:0
    s_add_u32 s5, s5, 63
    s_add_u32 s8, s8, s5
    v_add_u32_dpp v107, v107, v107 row_shr:4 row_mask:0xf bank_mask:0xf bound_ctrl:0
    s_andn2_b32 s8, s8, 63
    s_add_u32 s69, s69, s5
    v_add_u32_dpp v107, v107, v107 row_shr:8 row_mask:0xf bank_mask:0xf bound_ctrl:0
    s_add_u32 s69, s69, 1024
    s_andn2_b32 s69, s69, 63
    v_add_u32_dpp v107, v107, v107 row_bcast:15 row_mask:0xa bank_mask:0xf
    s_lshl_b32 s5, s3, 3
    s_nop 0
    v_add_u32_dpp v107, v107, v107 row_bcast:31 row_mask:0xc bank_mask:0xf
    s_nop 0
    s_nop 0
    v_readlane_b32 s7, v107, 63
    v_sub_u32 v107, v107, v105
    v_and_b32 v105, 0xffff, v107
    v_lshrrev_b32 v106, 16, v107
    v_add3_u32 v105, v105, s8, v100
    v_add3_u32 v106, v106, s69, v100
    s_mov_b64 exec, vcc
    ds_write_b32 v103, v105 offset:3072
    s_mov_b64 exec, s[70:71]
    ds_write_b32 v104, v106 offset:3072
    s_lshr_b32 s68, s7, 16
    s_and_b32 s7, s7, 0xffff
    s_mov_b64 exec, 0xffff
    s_add_u32 s6, s8, s7
    v_lshl_add_u32 v100, v1, 2, s6
    s_add_u32 s6, s69, s68
    v_lshl_add_u32 v101, v1, 2, s6
    v_mov_b32 v102, 2147483392
    v_mov_b32 v103, s5
    v_mov_b32 v104, s69
    v_mov_b32 v105, s68
    ds_write_b32 v100, v102 offset:16128
    ds_write_b32 v101, v102 offset:16128
    ds_write_b64 v103, v[104:105] offset:2368
    s_mov_b64 exec, -1
    s_waitcnt lgkmcnt(0)
    s_barrier
    s_mov_b64 exec, s[48:49]
    ds_read_b32 v44, v44 offset:3072
    s_mov_b64 exec, s[50:51]
    ds_read_b32 v45, v45 offset:3072
    s_mov_b64 exec, s[52:53]
    ds_read_b32 v46, v46 offset:3072
    s_mov_b64 exec, s[54:55]
    ds_read_b32 v47, v47 offset:3072
    s_mov_b64 exec, s[56:57]
    ds_read_b32 v48, v48 offset:3072
    s_mov_b64 exec, s[58:59]
    ds_read_b32 v49, v49 offset:3072
    s_mov_b64 exec, s[60:61]
    ds_read_b32 v50, v50 offset:3072
    s_mov_b64 exec, s[62:63]
    ds_read_b32 v51, v51 offset:3072
    s_mov_b64 exec, -1
    v_and_b32 v99, 1, v1
    v_mul_u32_u24 v99, 0x180, v99
    v_and_b32 v98, 0xf0, v2
    v_xor_b32 v99, v99, v98
    v_and_b32 v98, 0x200, v3
    v_or_b32 v99, v99, v98
    s_min_u32 s5, s10, 97
    s_mul_i32 s5, s5, 1040
    v_add_u32 v92, s5, v99
    s_min_u32 s5, s11, 97
    s_mul_i32 s5, s5, 1040
    v_add_u32 v93, s5, v99
    s_min_u32 s5, s12, 97
    s_mul_i32 s5, s5, 1040
    v_add_u32 v94, s5, v99
    s_min_u32 s5, s13, 97
    s_mul_i32 s5, s5, 1040
    v_add_u32 v95, s5, v99
    s_min_u32 s5, s14, 97
    s_mul_i32 s5, s5, 1040
    v_add_u32 v96, s5, v99
    s_min_u32 s5, s15, 97
    s_mul_i32 s5, s5, 1040
    v_add_u32 v97, s5, v99
    s_min_u32 s5, s96, 97
    s_mul_i32 s5, s5, 1040
    v_add_u32 v98, s5, v99
    v_add_u32 v99, s8, v2
    v_lshrrev_b32 v13, 2, v1
    s_lshr_b32 s5, s8, 1
    v_lshl_add_u32 v13, v13, 1, s5
    s_waitcnt lgkmcnt(0)
    v_add_u32_sdwa v36, v44, v36 dst_sel:DWORD dst_unused:UNUSED_PAD src0_sel:WORD_0 src1_sel:DWORD
    v_or_b32_sdwa v16, v16, v44 dst_sel:DWORD dst_unused:UNUSED_PAD src0_sel:DWORD src1_sel:WORD_1
    v_lshrrev_b32 v44, 1, v36
    v_add_u32_sdwa v37, v45, v37 dst_sel:DWORD dst_unused:UNUSED_PAD src0_sel:WORD_0 src1_sel:DWORD
    v_or_b32_sdwa v18, v18, v45 dst_sel:DWORD dst_unused:UNUSED_PAD src0_sel:DWORD src1_sel:WORD_1
    v_lshrrev_b32 v45, 1, v37
    v_add_u32_sdwa v38, v46, v38 dst_sel:DWORD dst_unused:UNUSED_PAD src0_sel:WORD_0 src1_sel:DWORD
    v_or_b32_sdwa v20, v20, v46 dst_sel:DWORD dst_unused:UNUSED_PAD src0_sel:DWORD src1_sel:WORD_1
    v_lshrrev_b32 v46, 1, v38
    v_add_u32_sdwa v39, v47, v39 dst_sel:DWORD dst_unused:UNUSED_PAD src0_sel:WORD_0 src1_sel:DWORD
    v_or_b32_sdwa v22, v22, v47 dst_sel:DWORD dst_unused:UNUSED_PAD src0_sel:DWORD src1_sel:WORD_1
    v_lshrrev_b32 v47, 1, v39
    v_add_u32_sdwa v40, v48, v40 dst_sel:DWORD dst_unused:UNUSED_PAD src0_sel:WORD_0 src1_sel:DWORD
    v_or_b32_sdwa v24, v24, v48 dst_sel:DWORD dst_unused:UNUSED_PAD src0_sel:DWORD src1_sel:WORD_1
    v_lshrrev_b32 v48, 1, v40
    v_add_u32_sdwa v41, v49, v41 dst_sel:DWORD dst_unused:UNUSED_PAD src0_sel:WORD_0 src1_sel:DWORD
    v_or_b32_sdwa v26, v26, v49 dst_sel:DWORD dst_unused:UNUSED_PAD src0_sel:DWORD src1_sel:WORD_1
    v_lshrrev_b32 v49, 1, v41
    v_add_u32_sdwa v42, v50, v42 dst_sel:DWORD dst_unused:UNUSED_PAD src0_sel:WORD_0 src1_sel:DWORD
    v_or_b32_sdwa v28, v28, v50 dst_sel:DWORD dst_unused:UNUSED_PAD src0_sel:DWORD src1_sel:WORD_1
    v_lshrrev_b32 v50, 1, v42
    v_add_u32_sdwa v43, v51, v43 dst_sel:DWORD dst_unused:UNUSED_PAD src0_sel:WORD_0 src1_sel:DWORD
    v_or_b32_sdwa v30, v30, v51 dst_sel:DWORD dst_unused:UNUSED_PAD src0_sel:DWORD src1_sel:WORD_1
    v_lshrrev_b32 v51, 1, v43
    s_mov_b64 exec, s[48:49]
    ds_write_b32 v36, v16 offset:16128
    ds_write_b16_d16_hi v44, v17 offset:7168
    s_mov_b64 exec, s[50:51]
    ds_write_b32 v37, v18 offset:16128
    ds_write_b16_d16_hi v45, v19 offset:7168
    s_mov_b64 exec, s[52:53]
    ds_write_b32 v38, v20 offset:16128
    ds_write_b16_d16_hi v46, v21 offset:7168
    s_mov_b64 exec, s[54:55]
    ds_write_b32 v39, v22 offset:16128
    ds_write_b16_d16_hi v47, v23 offset:7168
    s_mov_b64 exec, s[56:57]
    ds_write_b32 v40, v24 offset:16128
    ds_write_b16_d16_hi v48, v25 offset:7168
    s_mov_b64 exec, s[58:59]
    ds_write_b32 v41, v26 offset:16128
    ds_write_b16_d16_hi v49, v27 offset:7168
    s_mov_b64 exec, s[60:61]
    ds_write_b32 v42, v28 offset:16128
    ds_write_b16_d16_hi v50, v29 offset:7168
    s_mov_b64 exec, s[62:63]
    ds_write_b32 v43, v30 offset:16128
    ds_write_b16_d16_hi v51, v31 offset:7168
    s_mov_b64 exec, -1
    s_waitcnt lgkmcnt(0)
    s_barrier
    s_branch k2_join
k1_load:
    v_lshrrev_b32 v122, 4, v1
    v_lshlrev_b32 v121, 1, v122
    v_xor_b32 v121, v121, v1
    v_and_b32 v121, 15, v121
    v_lshlrev_b32 v121, 4, v121
    v_lshl_or_b32 v121, v122, 9, v121
    v_xor_b32 v122, 0x1080, v121
    s_and_b32 s5, s3, 3
    s_lshl_b32 s5, s5, 6
    v_xor_b32 v18, v12, v1
    v_and_b32 v18, 15, v18
    v_and_b32 v13, 48, v1
    v_or_b32 v18, v18, v13
    v_lshlrev_b32 v18, 4, v18
    v_xor_b32 v18, s5, v18
    s_mul_i32 s6, s2, 25088
    v_mov_b32 v19, v3
    s_waitcnt lgkmcnt(0)
    s_add_u32 s36, s16, s6
    s_addc_u32 s37, s17, 0
    s_mul_i32 s5, s2, 36864
    s_add_u32 s5, s5, 13631488
    s_add_u32 s40, s32, s5
    s_addc_u32 s41, s33, 0
    s_mov_b32 s88, s24
    s_mov_b32 s89, s25
    s_mul_i32 s5, s2, 50176
    s_add_u32 s44, s32, s5
    s_addc_u32 s45, s33, 0
    s_lshl_b32 s46, s4, 9
    s_mov_b32 s47, 0x20000
    s_add_u32 s80, s32, 33751040
    s_addc_u32 s81, s33, 0
    s_bfe_u32 s14, s3, 0x10002
    s_and_b32 s5, s3, 3
    v_bfe_u32 v13, v1, 2, 3
    v_lshlrev_b32 v2, 5, v13
    v_and_b32 v13, 3, v13
    v_lshl_add_u32 v2, v13, 8, v2
    v_lshl_add_u32 v2, v12, 11, v2
    v_and_b32 v13, 3, v1
    v_lshl_add_u32 v2, v13, 3, v2
    s_lshl_b32 s6, s14, 15
    s_add_u32 s6, s6, 65536
    v_add_u32 v2, s6, v2
    v_xor_b32 v3, 32, v2
    v_xor_b32 v4, 64, v2
    v_xor_b32 v5, 96, v2
    v_xor_b32 v6, 128, v2
    v_xor_b32 v7, 160, v2
    v_xor_b32 v8, 192, v2
    v_xor_b32 v9, 224, v2
    v_and_b32 v13, 15, v1
    v_xor_b32 v14, v12, v13
    v_lshlrev_b32 v14, 4, v14
    v_lshl_add_u32 v10, v13, 8, v14
    s_lshl_b32 s6, s5, 13
    s_add_u32 s6, s6, 39936
    v_add_u32 v10, s6, v10
    v_lshlrev_b32 v11, 4, v13
    v_lshl_add_u32 v11, v12, 11, v11
    s_lshl_b32 s62, s5, 14
    s_lshl_b32 s5, s14, 8
    s_add_u32 s6, s62, s5
    v_add_u32 v11, s6, v11
    s_bfe_u32 s5, s2, 0x30003
    s_lshl_b32 s5, s5, 13
    s_xor_b32 s62, s62, s5
    s_lshl_b32 s5, s3, 10
    s_sub_u32 s5, s5, 8192
    s_add_u32 m0, s5, 39936
    s_cmp_ge_u32 s3, 16
    s_barrier
    s_cbranch_scc1 k1_ldx
    buffer_load_dwordx4 v18, s[36:39], s5 offen lds
    s_add_u32 m0, m0, 8192
    s_add_u32 s5, s5, 8192
    buffer_load_dwordx4 v18, s[36:39], s5 offen lds
    s_add_u32 m0, m0, 8192
    s_add_u32 s5, s5, 8192
    buffer_load_dwordx4 v18, s[36:39], s5 offen lds
    s_cmp_eq_u32 s3, 9
    s_cbranch_scc1 k1_l14
    s_cmp_lg_u32 s3, 8
    s_cbranch_scc1 k1_ldx
    s_mov_b32 m0, 64512
    s_movk_i32 s5, 24576
    buffer_load_dwordx4 v18, s[36:39], s5 offen lds
    s_branch k1_ldx
k1_l14:
    s_mov_b32 m0, 1280
    s_mov_b32 exec_hi, 0
    s_mov_b32 s5, 131072
    buffer_load_dwordx4 v19, s[88:91], s5 offen lds
    s_mov_b32 m0, 1792
    s_nop 0
    global_load_lds_dwordx4 v19, s[26:27]
    s_mov_b64 exec, -1
k1_ldx:
    s_lshl_b32 s63, s14, 8
    s_mul_i32 s65, s14, 32640
    s_xor_b32 s5, s62, 0
    s_add_u32 s5, s5, s63
    s_lshr_b32 s6, s5, 1
    s_add_u32 s6, s6, s65
    s_add_u32 m0, s6, 65536
    s_nop 0
    buffer_load_dwordx4 v121, s[88:91], s5 offen offset:0 lds
    s_add_u32 m0, s6, 64512
    s_nop 0
    buffer_load_dwordx4 v121, s[88:91], s5 offen offset:2048 lds
    s_add_u32 m0, s6, 67584
    s_nop 0
    buffer_load_dwordx4 v122, s[88:91], s5 offen offset:0 lds
    s_add_u32 m0, s6, 66560
    s_nop 0
    buffer_load_dwordx4 v122, s[88:91], s5 offen offset:2048 lds
    s_xor_b32 s5, s62, 8192
    s_add_u32 s5, s5, s63
    s_lshr_b32 s6, s5, 1
    s_add_u32 s6, s6, s65
    s_add_u32 m0, s6, 65536
    s_nop 0
    buffer_load_dwordx4 v121, s[88:91], s5 offen offset:0 lds
    s_add_u32 m0, s6, 64512
    s_nop 0
    buffer_load_dwordx4 v121, s[88:91], s5 offen offset:2048 lds
    s_add_u32 m0, s6, 67584
    s_nop 0
    buffer_load_dwordx4 v122, s[88:91], s5 offen offset:0 lds
    s_add_u32 m0, s6, 66560
    s_nop 0
    buffer_load_dwordx4 v122, s[88:91], s5 offen offset:2048 lds
    s_cmp_eq_u32 s14, 0
    s_cselect_b32 s65, 16, 0x100
    s_lshl2_add_u32 s64, s65, 8
    s_waitcnt vmcnt(8)
    v_mov_b32 v13, 1
    s_mov_b64 exec, 1
    ds_add_u32 v15, v13 offset:2956
    s_mov_b64 exec, -1
    s_waitcnt vmcnt(0)
    v_mov_b32 v13, s65
    s_mov_b64 exec, 1
    ds_add_u32 v15, v13 offset:2956
    s_mov_b64 exec, -1
    s_mov_b32 s77, 400000
k1_pp:
    ds_read_b32 v13, v15 offset:2956
    s_sub_u32 s77, s77, 1
    s_cbranch_scc1 k1_pp_ok
    s_waitcnt lgkmcnt(0)
    v_readfirstlane_b32 s5, v13
    s_and_b32 s5, s5, s64
    s_cmp_lg_u32 s5, s64
    s_cbranch_scc1 k1_pp
k1_pp_ok:
    s_setprio 1
    ds_read_b128 v[16:19], v10 offset:0
    ds_read_b128 v[20:23], v10 offset:4096
    ds_read_b64_tr_b16 v[32:33], v2 offset:0
    ds_read_b64_tr_b16 v[34:35], v2 offset:1024
    ds_read_b64_tr_b16 v[36:37], v3 offset:0
    ds_read_b64_tr_b16 v[38:39], v3 offset:1024
    ds_read_b64_tr_b16 v[40:41], v4 offset:0
    ds_read_b64_tr_b16 v[42:43], v4 offset:1024
    ds_read_b64_tr_b16 v[44:45], v5 offset:0
    ds_read_b64_tr_b16 v[46:47], v5 offset:1024
    ds_read_b64_tr_b16 v[48:49], v6 offset:0
    ds_read_b64_tr_b16 v[50:51], v6 offset:1024
    ds_read_b64_tr_b16 v[52:53], v7 offset:0
    ds_read_b64_tr_b16 v[54:55], v7 offset:1024
    s_waitcnt lgkmcnt(10)
    v_mfma_f32_16x16x32_bf16 v[64:67], v[16:19], v[32:35], 0
    v_mfma_f32_16x16x32_bf16 v[96:99], v[20:23], v[32:35], 0
    ds_read_b64_tr_b16 v[56:57], v8 offset:0
    ds_read_b64_tr_b16 v[58:59], v8 offset:1024
    v_xor_b32 v12, 64, v10
    ds_read_b128 v[24:27], v12 offset:0
    ds_read_b128 v[28:31], v12 offset:4096
    s_waitcnt lgkmcnt(12)
    v_mfma_f32_16x16x32_bf16 v[68:71], v[16:19], v[36:39], 0
    v_mfma_f32_16x16x32_bf16 v[100:103], v[20:23], v[36:39], 0
    ds_read_b64_tr_b16 v[60:61], v9 offset:0
    ds_read_b64_tr_b16 v[62:63], v9 offset:1024
    s_waitcnt lgkmcnt(12)
    v_mfma_f32_16x16x32_bf16 v[72:75], v[16:19], v[40:43], 0
    v_mfma_f32_16x16x32_bf16 v[104:107], v[20:23], v[40:43], 0
    ds_read_b64_tr_b16 v[32:33], v2 offset:8192
    ds_read_b64_tr_b16 v[34:35], v2 offset:9216
    s_waitcnt lgkmcnt(12)
    v_mfma_f32_16x16x32_bf16 v[76:79], v[16:19], v[44:47], 0
    v_mfma_f32_16x16x32_bf16 v[108:111], v[20:23], v[44:47], 0
    ds_read_b64_tr_b16 v[36:37], v3 offset:8192
    ds_read_b64_tr_b16 v[38:39], v3 offset:9216
    s_waitcnt lgkmcnt(12)
    v_mfma_f32_16x16x32_bf16 v[80:83], v[16:19], v[48:51], 0
    v_mfma_f32_16x16x32_bf16 v[112:115], v[20:23], v[48:51], 0
    ds_read_b64_tr_b16 v[40:41], v4 offset:8192
    ds_read_b64_tr_b16 v[42:43], v4 offset:9216
    s_waitcnt lgkmcnt(12)
    v_mfma_f32_16x16x32_bf16 v[84:87], v[16:19], v[52:55], 0
    v_mfma_f32_16x16x32_bf16 v[116:119], v[20:23], v[52:55], 0
    ds_read_b64_tr_b16 v[44:45], v5 offset:8192
    ds_read_b64_tr_b16 v[46:47], v5 offset:9216
    s_waitcnt lgkmcnt(12)
    v_mfma_f32_16x16x32_bf16 v[88:91], v[16:19], v[56:59], 0
    v_mfma_f32_16x16x32_bf16 v[120:123], v[20:23], v[56:59], 0
    ds_read_b64_tr_b16 v[48:49], v6 offset:8192
    ds_read_b64_tr_b16 v[50:51], v6 offset:9216
    s_waitcnt lgkmcnt(10)
    v_mfma_f32_16x16x32_bf16 v[92:95], v[16:19], v[60:63], 0
    v_mfma_f32_16x16x32_bf16 v[124:127], v[20:23], v[60:63], 0
    ds_read_b64_tr_b16 v[52:53], v7 offset:8192
    ds_read_b64_tr_b16 v[54:55], v7 offset:9216
    v_xor_b32 v13, 128, v10
    ds_read_b128 v[16:19], v13 offset:0
    ds_read_b128 v[20:23], v13 offset:4096
    s_waitcnt lgkmcnt(12)
    v_mfma_f32_16x16x32_bf16 v[64:67], v[24:27], v[32:35], v[64:67]
    v_mfma_f32_16x16x32_bf16 v[96:99], v[28:31], v[32:35], v[96:99]
    ds_read_b64_tr_b16 v[56:57], v8 offset:8192
    ds_read_b64_tr_b16 v[58:59], v8 offset:9216
    s_waitcnt lgkmcnt(12)
    v_mfma_f32_16x16x32_bf16 v[68:71], v[24:27], v[36:39], v[68:71]
    v_mfma_f32_16x16x32_bf16 v[100:103], v[28:31], v[36:39], v[100:103]
    ds_read_b64_tr_b16 v[60:61], v9 offset:8192
    ds_read_b64_tr_b16 v[62:63], v9 offset:9216
    s_waitcnt lgkmcnt(12)
    v_mfma_f32_16x16x32_bf16 v[72:75], v[24:27], v[40:43], v[72:75]
    v_mfma_f32_16x16x32_bf16 v[104:107], v[28:31], v[40:43], v[104:107]
    ds_read_b64_tr_b16 v[32:33], v2 offset:16384
    ds_read_b64_tr_b16 v[34:35], v2 offset:17408
    s_waitcnt lgkmcnt(12)
    v_mfma_f32_16x16x32_bf16 v[76:79], v[24:27], v[44:47], v[76:79]
    v_mfma_f32_16x16x32_bf16 v[108:111], v[28:31], v[44:47], v[108:111]
    ds_read_b64_tr_b16 v[36:37], v3 offset:16384
    ds_read_b64_tr_b16 v[38:39], v3 offset:17408
    s_waitcnt lgkmcnt(12)
    v_mfma_f32_16x16x32_bf16 v[80:83], v[24:27], v[48:51], v[80:83]
    v_mfma_f32_16x16x32_bf16 v[112:115], v[28:31], v[48:51], v[112:115]
    ds_read_b64_tr_b16 v[40:41], v4 offset:16384
    ds_read_b64_tr_b16 v[42:43], v4 offset:17408
    s_waitcnt lgkmcnt(12)
    v_mfma_f32_16x16x32_bf16 v[84:87], v[24:27], v[52:55], v[84:87]
    v_mfma_f32_16x16x32_bf16 v[116:119], v[28:31], v[52:55], v[116:119]
    ds_read_b64_tr_b16 v[44:45], v5 offset:16384
    ds_read_b64_tr_b16 v[46:47], v5 offset:17408
    s_waitcnt lgkmcnt(10)
    v_mfma_f32_16x16x32_bf16 v[88:91], v[24:27], v[56:59], v[88:91]
    v_mfma_f32_16x16x32_bf16 v[120:123], v[28:31], v[56:59], v[120:123]
    ds_read_b64_tr_b16 v[48:49], v6 offset:16384
    ds_read_b64_tr_b16 v[50:51], v6 offset:17408
    s_waitcnt lgkmcnt(10)
    v_mfma_f32_16x16x32_bf16 v[92:95], v[24:27], v[60:63], v[92:95]
    v_mfma_f32_16x16x32_bf16 v[124:127], v[28:31], v[60:63], v[124:127]
    ds_read_b64_tr_b16 v[52:53], v7 offset:16384
    ds_read_b64_tr_b16 v[54:55], v7 offset:17408
    v_xor_b32 v14, 192, v10
    ds_read_b128 v[24:27], v14 offset:0
    ds_read_b128 v[28:31], v14 offset:4096
    s_waitcnt lgkmcnt(12)
    v_mfma_f32_16x16x32_bf16 v[64:67], v[16:19], v[32:35], v[64:67]
    v_mfma_f32_16x16x32_bf16 v[96:99], v[20:23], v[32:35], v[96:99]
    ds_read_b64_tr_b16 v[56:57], v8 offset:16384
    ds_read_b64_tr_b16 v[58:59], v8 offset:17408
    s_waitcnt lgkmcnt(12)
    v_mfma_f32_16x16x32_bf16 v[68:71], v[16:19], v[36:39], v[68:71]
    v_mfma_f32_16x16x32_bf16 v[100:103], v[20:23], v[36:39], v[100:103]
    ds_read_b64_tr_b16 v[60:61], v9 offset:16384
    ds_read_b64_tr_b16 v[62:63], v9 offset:17408
    s_waitcnt lgkmcnt(12)
    v_mfma_f32_16x16x32_bf16 v[72:75], v[16:19], v[40:43], v[72:75]
    v_mfma_f32_16x16x32_bf16 v[104:107], v[20:23], v[40:43], v[104:107]
    ds_read_b64_tr_b16 v[32:33], v2 offset:24576
    ds_read_b64_tr_b16 v[34:35], v2 offset:25600
    s_waitcnt lgkmcnt(12)
    v_mfma_f32_16x16x32_bf16 v[76:79], v[16:19], v[44:47], v[76:79]
    v_mfma_f32_16x16x32_bf16 v[108:111], v[20:23], v[44:47], v[108:111]
    ds_read_b64_tr_b16 v[36:37], v3 offset:24576
    ds_read_b64_tr_b16 v[38:39], v3 offset:25600
    s_waitcnt lgkmcnt(12)
    v_mfma_f32_16x16x32_bf16 v[80:83], v[16:19], v[48:51], v[80:83]
    v_mfma_f32_16x16x32_bf16 v[112:115], v[20:23], v[48:51], v[112:115]
    ds_read_b64_tr_b16 v[40:41], v4 offset:24576
    ds_read_b64_tr_b16 v[42:43], v4 offset:25600
    s_waitcnt lgkmcnt(12)
    v_mfma_f32_16x16x32_bf16 v[84:87], v[16:19], v[52:55], v[84:87]
    v_mfma_f32_16x16x32_bf16 v[116:119], v[20:23], v[52:55], v[116:119]
    ds_read_b64_tr_b16 v[44:45], v5 offset:24576
    ds_read_b64_tr_b16 v[46:47], v5 offset:25600
    s_waitcnt lgkmcnt(10)
    v_mfma_f32_16x16x32_bf16 v[88:91], v[16:19], v[56:59], v[88:91]
    v_mfma_f32_16x16x32_bf16 v[120:123], v[20:23], v[56:59], v[120:123]
    ds_read_b64_tr_b16 v[48:49], v6 offset:24576
    ds_read_b64_tr_b16 v[50:51], v6 offset:25600
    s_waitcnt lgkmcnt(10)
    v_mfma_f32_16x16x32_bf16 v[92:95], v[16:19], v[60:63], v[92:95]
    v_mfma_f32_16x16x32_bf16 v[124:127], v[20:23], v[60:63], v[124:127]
    ds_read_b64_tr_b16 v[52:53], v7 offset:24576
    ds_read_b64_tr_b16 v[54:55], v7 offset:25600
    s_waitcnt lgkmcnt(10)
    v_mfma_f32_16x16x32_bf16 v[64:67], v[24:27], v[32:35], v[64:67]
    ds_read_b64_tr_b16 v[56:57], v8 offset:24576
    ds_read_b64_tr_b16 v[58:59], v8 offset:25600
    s_waitcnt lgkmcnt(10)
    v_mfma_f32_16x16x32_bf16 v[68:71], v[24:27], v[36:39], v[68:71]
    ds_read_b64_tr_b16 v[60:61], v9 offset:24576
    ds_read_b64_tr_b16 v[62:63], v9 offset:25600
    s_waitcnt lgkmcnt(10)
    v_mfma_f32_16x16x32_bf16 v[72:75], v[24:27], v[40:43], v[72:75]
    s_waitcnt lgkmcnt(8)
    v_mfma_f32_16x16x32_bf16 v[76:79], v[24:27], v[44:47], v[76:79]
    s_waitcnt lgkmcnt(6)
    v_mfma_f32_16x16x32_bf16 v[80:83], v[24:27], v[48:51], v[80:83]
    s_waitcnt lgkmcnt(4)
    v_mfma_f32_16x16x32_bf16 v[84:87], v[24:27], v[52:55], v[84:87]
    s_waitcnt lgkmcnt(2)
    v_mfma_f32_16x16x32_bf16 v[88:91], v[24:27], v[56:59], v[88:91]
    s_waitcnt lgkmcnt(0)
    v_mfma_f32_16x16x32_bf16 v[92:95], v[24:27], v[60:63], v[92:95]
    s_movk_i32 s66, 0x2000
    v_mfma_f32_16x16x32_bf16 v[96:99], v[28:31], v[32:35], v[96:99]
    v_mfma_f32_16x16x32_bf16 v[100:103], v[28:31], v[36:39], v[100:103]
    v_mfma_f32_16x16x32_bf16 v[104:107], v[28:31], v[40:43], v[104:107]
    v_mul_f32 v64, s98, v64
    v_mul_f32 v65, s98, v65
    v_mul_f32 v66, s98, v66
    v_mul_f32 v67, s98, v67
    v_mfma_f32_16x16x32_bf16 v[108:111], v[28:31], v[44:47], v[108:111]
    v_mul_f32 v68, s98, v68
    v_mul_f32 v69, s98, v69
    v_mul_f32 v70, s98, v70
    v_mul_f32 v71, s98, v71
    v_mfma_f32_16x16x32_bf16 v[112:115], v[28:31], v[48:51], v[112:115]
    v_mul_f32 v72, s98, v72
    v_mul_f32 v73, s98, v73
    v_mul_f32 v74, s98, v74
    v_mul_f32 v75, s98, v75
    v_mfma_f32_16x16x32_bf16 v[116:119], v[28:31], v[52:55], v[116:119]
    v_mul_f32 v76, s98, v76
    v_mul_f32 v77, s98, v77
    v_mul_f32 v78, s98, v78
    v_mul_f32 v79, s98, v79
    v_mfma_f32_16x16x32_bf16 v[120:123], v[28:31], v[56:59], v[120:123]
    v_mul_f32 v80, s98, v80
    v_mul_f32 v81, s98, v81
    v_mul_f32 v82, s98, v82
    v_mul_f32 v83, s98, v83
    v_mfma_f32_16x16x32_bf16 v[124:127], v[28:31], v[60:63], v[124:127]
    v_mul_f32 v84, s98, v84
    v_mul_f32 v85, s98, v85
    v_mul_f32 v86, s98, v86
    v_mul_f32 v87, s98, v87
    v_mul_f32 v88, s98, v88
    v_mul_f32 v89, s98, v89
    v_mul_f32 v90, s98, v90
    v_mul_f32 v91, s98, v91
    v_mul_f32 v92, s98, v92
    v_mul_f32 v93, s98, v93
    v_mul_f32 v94, s98, v94
    v_mul_f32 v95, s98, v95
    v_cvt_pk_bf16_f32 v32, v64, v68
    v_cvt_pk_bf16_f32 v33, v72, v76
    v_cvt_pk_bf16_f32 v34, v80, v84
    v_cvt_pk_bf16_f32 v35, v88, v92
    buffer_store_dwordx4 v[32:35], v11, s[44:47], 0 offen offset:0 sc1
    v_cvt_pk_bf16_f32 v36, v65, v69
    v_cvt_pk_bf16_f32 v37, v73, v77
    v_cvt_pk_bf16_f32 v38, v81, v85
    v_cvt_pk_bf16_f32 v39, v89, v93
    buffer_store_dwordx4 v[36:39], v11, s[44:47], 0 offen offset:512 sc1
    v_cvt_pk_bf16_f32 v40, v66, v70
    v_cvt_pk_bf16_f32 v41, v74, v78
    v_cvt_pk_bf16_f32 v42, v82, v86
    v_cvt_pk_bf16_f32 v43, v90, v94
    buffer_store_dwordx4 v[40:43], v11, s[44:47], 0 offen offset:1024 sc1
    v_cvt_pk_bf16_f32 v44, v67, v71
    v_cvt_pk_bf16_f32 v45, v75, v79
    v_cvt_pk_bf16_f32 v46, v83, v87
    v_cvt_pk_bf16_f32 v47, v91, v95
    buffer_store_dwordx4 v[44:47], v11, s[44:47], 0 offen offset:1536 sc1
    v_pk_mul_f32 v[96:97], s[98:99], v[96:97]
    v_pk_mul_f32 v[98:99], s[98:99], v[98:99]
    v_pk_mul_f32 v[100:101], s[98:99], v[100:101]
    v_pk_mul_f32 v[102:103], s[98:99], v[102:103]
    v_pk_mul_f32 v[104:105], s[98:99], v[104:105]
    v_pk_mul_f32 v[106:107], s[98:99], v[106:107]
    v_pk_mul_f32 v[108:109], s[98:99], v[108:109]
    v_pk_mul_f32 v[110:111], s[98:99], v[110:111]
    v_pk_mul_f32 v[112:113], s[98:99], v[112:113]
    v_pk_mul_f32 v[114:115], s[98:99], v[114:115]
    v_pk_mul_f32 v[116:117], s[98:99], v[116:117]
    v_pk_mul_f32 v[118:119], s[98:99], v[118:119]
    v_pk_mul_f32 v[120:121], s[98:99], v[120:121]
    v_pk_mul_f32 v[122:123], s[98:99], v[122:123]
    v_pk_mul_f32 v[124:125], s[98:99], v[124:125]
    v_pk_mul_f32 v[126:127], s[98:99], v[126:127]
    v_cvt_pk_bf16_f32 v48, v96, v100
    v_cvt_pk_bf16_f32 v49, v104, v108
    v_cvt_pk_bf16_f32 v50, v112, v116
    v_cvt_pk_bf16_f32 v51, v120, v124
    buffer_store_dwordx4 v[48:51], v11, s[44:47], s66 offen offset:0 sc1
    v_cvt_pk_bf16_f32 v52, v97, v101
    v_cvt_pk_bf16_f32 v53, v105, v109
    v_cvt_pk_bf16_f32 v54, v113, v117
    v_cvt_pk_bf16_f32 v55, v121, v125
    buffer_store_dwordx4 v[52:55], v11, s[44:47], s66 offen offset:512 sc1
    v_cvt_pk_bf16_f32 v56, v98, v102
    v_cvt_pk_bf16_f32 v57, v106, v110
    v_cvt_pk_bf16_f32 v58, v114, v118
    v_cvt_pk_bf16_f32 v59, v122, v126
    buffer_store_dwordx4 v[56:59], v11, s[44:47], s66 offen offset:1024 sc1
    v_cvt_pk_bf16_f32 v60, v99, v103
    v_cvt_pk_bf16_f32 v61, v107, v111
    v_cvt_pk_bf16_f32 v62, v115, v119
    v_cvt_pk_bf16_f32 v63, v123, v127
    buffer_store_dwordx4 v[60:63], v11, s[44:47], s66 offen offset:1536 sc1
    s_cmp_eq_u32 s14, 0
    s_mov_b32 s6, -91136
    s_cselect_b32 s6, 65536, s6
    v_add_u32 v2, s6, v2
    v_add_u32 v3, s6, v3
    v_add_u32 v4, s6, v4
    v_add_u32 v5, s6, v5
    v_add_u32 v6, s6, v6
    v_add_u32 v7, s6, v7
    v_add_u32 v8, s6, v8
    v_add_u32 v9, s6, v9
    s_setprio 0
    s_mov_b32 s77, 400000
k1_pq:
    ds_read_b32 v13, v15 offset:2956
    s_sub_u32 s77, s77, 1
    s_cbranch_scc1 k1_pq_ok
    s_waitcnt lgkmcnt(0)
    v_readfirstlane_b32 s5, v13
    s_and_b32 s5, s5, 32768
    s_cmp_lg_u32 s5, 32768
    s_cbranch_scc1 k1_pq
k1_pq_ok:
    ds_read_b128 v[16:19], v10 offset:0
    ds_read_b128 v[20:23], v10 offset:4096
    ds_read_b64_tr_b16 v[32:33], v2 offset:0
    ds_read_b64_tr_b16 v[34:35], v2 offset:1024
    ds_read_b64_tr_b16 v[36:37], v3 offset:0
    ds_read_b64_tr_b16 v[38:39], v3 offset:1024
    ds_read_b64_tr_b16 v[40:41], v4 offset:0
    ds_read_b64_tr_b16 v[42:43], v4 offset:1024
    ds_read_b64_tr_b16 v[44:45], v5 offset:0
    ds_read_b64_tr_b16 v[46:47], v5 offset:1024
    ds_read_b64_tr_b16 v[48:49], v6 offset:0
    ds_read_b64_tr_b16 v[50:51], v6 offset:1024
    ds_read_b64_tr_b16 v[52:53], v7 offset:0
    ds_read_b64_tr_b16 v[54:55], v7 offset:1024
    s_waitcnt lgkmcnt(10)
    v_mfma_f32_16x16x32_bf16 v[64:67], v[16:19], v[32:35], 0
    v_mfma_f32_16x16x32_bf16 v[96:99], v[20:23], v[32:35], 0
    ds_read_b64_tr_b16 v[56:57], v8 offset:0
    ds_read_b64_tr_b16 v[58:59], v8 offset:1024
    v_xor_b32 v12, 64, v10
    ds_read_b128 v[24:27], v12 offset:0
    ds_read_b128 v[28:31], v12 offset:4096
    s_waitcnt lgkmcnt(12)
    v_mfma_f32_16x16x32_bf16 v[68:71], v[16:19], v[36:39], 0
    v_mfma_f32_16x16x32_bf16 v[100:103], v[20:23], v[36:39], 0
    ds_read_b64_tr_b16 v[60:61], v9 offset:0
    ds_read_b64_tr_b16 v[62:63], v9 offset:1024
    s_waitcnt lgkmcnt(12)
    v_mfma_f32_16x16x32_bf16 v[72:75], v[16:19], v[40:43], 0
    v_mfma_f32_16x16x32_bf16 v[104:107], v[20:23], v[40:43], 0
    ds_read_b64_tr_b16 v[32:33], v2 offset:8192
    ds_read_b64_tr_b16 v[34:35], v2 offset:9216
    s_waitcnt lgkmcnt(12)
    v_mfma_f32_16x16x32_bf16 v[76:79], v[16:19], v[44:47], 0
    v_mfma_f32_16x16x32_bf16 v[108:111], v[20:23], v[44:47], 0
    ds_read_b64_tr_b16 v[36:37], v3 offset:8192
    ds_read_b64_tr_b16 v[38:39], v3 offset:9216
    s_waitcnt lgkmcnt(12)
    v_mfma_f32_16x16x32_bf16 v[80:83], v[16:19], v[48:51], 0
    v_mfma_f32_16x16x32_bf16 v[112:115], v[20:23], v[48:51], 0
    ds_read_b64_tr_b16 v[40:41], v4 offset:8192
    ds_read_b64_tr_b16 v[42:43], v4 offset:9216
    s_waitcnt lgkmcnt(12)
    v_mfma_f32_16x16x32_bf16 v[84:87], v[16:19], v[52:55], 0
    v_mfma_f32_16x16x32_bf16 v[116:119], v[20:23], v[52:55], 0
    ds_read_b64_tr_b16 v[44:45], v5 offset:8192
    ds_read_b64_tr_b16 v[46:47], v5 offset:9216
    s_waitcnt lgkmcnt(12)
    v_mfma_f32_16x16x32_bf16 v[88:91], v[16:19], v[56:59], 0
    v_mfma_f32_16x16x32_bf16 v[120:123], v[20:23], v[56:59], 0
    ds_read_b64_tr_b16 v[48:49], v6 offset:8192
    ds_read_b64_tr_b16 v[50:51], v6 offset:9216
    s_waitcnt lgkmcnt(10)
    v_mfma_f32_16x16x32_bf16 v[92:95], v[16:19], v[60:63], 0
    v_mfma_f32_16x16x32_bf16 v[124:127], v[20:23], v[60:63], 0
    ds_read_b64_tr_b16 v[52:53], v7 offset:8192
    ds_read_b64_tr_b16 v[54:55], v7 offset:9216
    v_xor_b32 v13, 128, v10
    ds_read_b128 v[16:19], v13 offset:0
    ds_read_b128 v[20:23], v13 offset:4096
    s_waitcnt lgkmcnt(12)
    v_mfma_f32_16x16x32_bf16 v[64:67], v[24:27], v[32:35], v[64:67]
    v_mfma_f32_16x16x32_bf16 v[96:99], v[28:31], v[32:35], v[96:99]
    ds_read_b64_tr_b16 v[56:57], v8 offset:8192
    ds_read_b64_tr_b16 v[58:59], v8 offset:9216
    s_waitcnt lgkmcnt(12)
    v_mfma_f32_16x16x32_bf16 v[68:71], v[24:27], v[36:39], v[68:71]
    v_mfma_f32_16x16x32_bf16 v[100:103], v[28:31], v[36:39], v[100:103]
    ds_read_b64_tr_b16 v[60:61], v9 offset:8192
    ds_read_b64_tr_b16 v[62:63], v9 offset:9216
    s_waitcnt lgkmcnt(12)
    v_mfma_f32_16x16x32_bf16 v[72:75], v[24:27], v[40:43], v[72:75]
    v_mfma_f32_16x16x32_bf16 v[104:107], v[28:31], v[40:43], v[104:107]
    ds_read_b64_tr_b16 v[32:33], v2 offset:16384
    ds_read_b64_tr_b16 v[34:35], v2 offset:17408
    s_waitcnt lgkmcnt(12)
    v_mfma_f32_16x16x32_bf16 v[76:79], v[24:27], v[44:47], v[76:79]
    v_mfma_f32_16x16x32_bf16 v[108:111], v[28:31], v[44:47], v[108:111]
    ds_read_b64_tr_b16 v[36:37], v3 offset:16384
    ds_read_b64_tr_b16 v[38:39], v3 offset:17408
    s_waitcnt lgkmcnt(12)
    v_mfma_f32_16x16x32_bf16 v[80:83], v[24:27], v[48:51], v[80:83]
    v_mfma_f32_16x16x32_bf16 v[112:115], v[28:31], v[48:51], v[112:115]
    ds_read_b64_tr_b16 v[40:41], v4 offset:16384
    ds_read_b64_tr_b16 v[42:43], v4 offset:17408
    v_mov_b32 v11, 1
    s_mov_b64 exec, 1
    s_waitcnt vmcnt(0)
    ds_add_rtn_u32 v12, v15, v11 offset:2972
    s_mov_b64 exec, -1
    s_waitcnt lgkmcnt(13)
    v_mfma_f32_16x16x32_bf16 v[84:87], v[24:27], v[52:55], v[84:87]
    v_mfma_f32_16x16x32_bf16 v[116:119], v[28:31], v[52:55], v[116:119]
    ds_read_b64_tr_b16 v[44:45], v5 offset:16384
    ds_read_b64_tr_b16 v[46:47], v5 offset:17408
    s_waitcnt lgkmcnt(11)
    v_mfma_f32_16x16x32_bf16 v[88:91], v[24:27], v[56:59], v[88:91]
    v_mfma_f32_16x16x32_bf16 v[120:123], v[28:31], v[56:59], v[120:123]
    ds_read_b64_tr_b16 v[48:49], v6 offset:16384
    ds_read_b64_tr_b16 v[50:51], v6 offset:17408
    s_waitcnt lgkmcnt(11)
    v_mfma_f32_16x16x32_bf16 v[92:95], v[24:27], v[60:63], v[92:95]
    v_mfma_f32_16x16x32_bf16 v[124:127], v[28:31], v[60:63], v[124:127]
    ds_read_b64_tr_b16 v[52:53], v7 offset:16384
    ds_read_b64_tr_b16 v[54:55], v7 offset:17408
    v_xor_b32 v14, 192, v10
    ds_read_b128 v[24:27], v14 offset:0
    ds_read_b128 v[28:31], v14 offset:4096
    s_waitcnt lgkmcnt(8)
    v_readfirstlane_b32 s15, v12
    s_cmp_lg_u32 s15, 8
    s_cbranch_scc1 k1_pa
    s_and_b32 s5, s2, 15
    s_lshl_b32 s5, s5, 7
    v_mov_b32 v12, s5
    s_mov_b64 exec, 1
    global_atomic_add v12, v11, s[80:81] sc1
    s_mov_b64 exec, -1
k1_pa:
    v_mfma_f32_16x16x32_bf16 v[64:67], v[16:19], v[32:35], v[64:67]
    v_mfma_f32_16x16x32_bf16 v[96:99], v[20:23], v[32:35], v[96:99]
    ds_read_b64_tr_b16 v[56:57], v8 offset:16384
    ds_read_b64_tr_b16 v[58:59], v8 offset:17408
    v_mfma_f32_16x16x32_bf16 v[68:71], v[16:19], v[36:39], v[68:71]
    v_mfma_f32_16x16x32_bf16 v[100:103], v[20:23], v[36:39], v[100:103]
    ds_read_b64_tr_b16 v[60:61], v9 offset:16384
    ds_read_b64_tr_b16 v[62:63], v9 offset:17408
    v_mfma_f32_16x16x32_bf16 v[72:75], v[16:19], v[40:43], v[72:75]
    v_mfma_f32_16x16x32_bf16 v[104:107], v[20:23], v[40:43], v[104:107]
    ds_read_b64_tr_b16 v[32:33], v2 offset:24576
    ds_read_b64_tr_b16 v[34:35], v2 offset:25600
    s_waitcnt lgkmcnt(12)
    v_mfma_f32_16x16x32_bf16 v[76:79], v[16:19], v[44:47], v[76:79]
    v_mfma_f32_16x16x32_bf16 v[108:111], v[20:23], v[44:47], v[108:111]
    ds_read_b64_tr_b16 v[36:37], v3 offset:24576
    ds_read_b64_tr_b16 v[38:39], v3 offset:25600
    s_waitcnt lgkmcnt(12)
    v_mfma_f32_16x16x32_bf16 v[80:83], v[16:19], v[48:51], v[80:83]
    v_mfma_f32_16x16x32_bf16 v[112:115], v[20:23], v[48:51], v[112:115]
    ds_read_b64_tr_b16 v[40:41], v4 offset:24576
    ds_read_b64_tr_b16 v[42:43], v4 offset:25600
    s_waitcnt lgkmcnt(12)
    v_mfma_f32_16x16x32_bf16 v[84:87], v[16:19], v[52:55], v[84:87]
    v_mfma_f32_16x16x32_bf16 v[116:119], v[20:23], v[52:55], v[116:119]
    ds_read_b64_tr_b16 v[44:45], v5 offset:24576
    ds_read_b64_tr_b16 v[46:47], v5 offset:25600
    s_waitcnt lgkmcnt(10)
    v_mfma_f32_16x16x32_bf16 v[88:91], v[16:19], v[56:59], v[88:91]
    v_mfma_f32_16x16x32_bf16 v[120:123], v[20:23], v[56:59], v[120:123]
    ds_read_b64_tr_b16 v[48:49], v6 offset:24576
    ds_read_b64_tr_b16 v[50:51], v6 offset:25600
    s_waitcnt lgkmcnt(10)
    v_mfma_f32_16x16x32_bf16 v[92:95], v[16:19], v[60:63], v[92:95]
    v_mfma_f32_16x16x32_bf16 v[124:127], v[20:23], v[60:63], v[124:127]
    ds_read_b64_tr_b16 v[52:53], v7 offset:24576
    ds_read_b64_tr_b16 v[54:55], v7 offset:25600
    s_waitcnt lgkmcnt(10)
    v_mfma_f32_16x16x32_bf16 v[64:67], v[24:27], v[32:35], v[64:67]
    ds_read_b64_tr_b16 v[56:57], v8 offset:24576
    ds_read_b64_tr_b16 v[58:59], v8 offset:25600
    s_waitcnt lgkmcnt(10)
    v_mfma_f32_16x16x32_bf16 v[68:71], v[24:27], v[36:39], v[68:71]
    ds_read_b64_tr_b16 v[60:61], v9 offset:24576
    ds_read_b64_tr_b16 v[62:63], v9 offset:25600
    s_waitcnt lgkmcnt(10)
    v_mfma_f32_16x16x32_bf16 v[72:75], v[24:27], v[40:43], v[72:75]
    s_waitcnt lgkmcnt(8)
    v_mfma_f32_16x16x32_bf16 v[76:79], v[24:27], v[44:47], v[76:79]
    s_waitcnt lgkmcnt(6)
    v_mfma_f32_16x16x32_bf16 v[80:83], v[24:27], v[48:51], v[80:83]
    s_waitcnt lgkmcnt(4)
    v_mfma_f32_16x16x32_bf16 v[84:87], v[24:27], v[52:55], v[84:87]
    s_waitcnt lgkmcnt(2)
    v_mfma_f32_16x16x32_bf16 v[88:91], v[24:27], v[56:59], v[88:91]
    s_waitcnt lgkmcnt(0)
    v_mfma_f32_16x16x32_bf16 v[92:95], v[24:27], v[60:63], v[92:95]
    v_and_b32 v14, 15, v1
    s_lshl_b32 s5, s14, 8
    v_lshl_add_u32 v13, v14, 1, s5
    v_mfma_f32_16x16x32_bf16 v[96:99], v[28:31], v[32:35], v[96:99]
    ds_read_u16 v16, v13 offset:1792
    v_mfma_f32_16x16x32_bf16 v[100:103], v[28:31], v[36:39], v[100:103]
    ds_read_u16 v17, v13 offset:1824
    v_mfma_f32_16x16x32_bf16 v[104:107], v[28:31], v[40:43], v[104:107]
    ds_read_u16 v18, v13 offset:1856
    v_mfma_f32_16x16x32_bf16 v[108:111], v[28:31], v[44:47], v[108:111]
    ds_read_u16 v19, v13 offset:1888
    v_mfma_f32_16x16x32_bf16 v[112:115], v[28:31], v[48:51], v[112:115]
    ds_read_u16 v20, v13 offset:1920
    v_mfma_f32_16x16x32_bf16 v[116:119], v[28:31], v[52:55], v[116:119]
    ds_read_u16 v21, v13 offset:1952
    v_mfma_f32_16x16x32_bf16 v[120:123], v[28:31], v[56:59], v[120:123]
    ds_read_u16 v22, v13 offset:1984
    v_mfma_f32_16x16x32_bf16 v[124:127], v[28:31], v[60:63], v[124:127]
    ds_read_u16 v23, v13 offset:2016
    v_lshlrev_b32 v3, 4, v1
    v_lshlrev_b32 v2, 3, v1
    v_lshrrev_b32 v13, 4, v1
    v_mul_u32_u24 v8, 4160, v13
    s_and_b32 s5, s3, 3
    s_mul_i32 s6, s5, 33280
    s_lshl_b32 s5, s14, 9
    s_add_u32 s6, s6, s5
    s_add_u32 s6, s6, 59648
    v_add_u32 v8, s6, v8
    v_xor_b32 v13, 8, v14
    v_lshl_add_u32 v9, v13, 4, v8
    v_lshl_add_u32 v8, v14, 4, v8
    v_and_b32 v24, 30, v1
    v_lshrrev_b32 v25, 5, v1
    v_lshl_add_u32 v24, v25, 8, v24
    v_and_b32 v25, 1, v1
    v_lshl_add_u32 v28, v25, 7, v24
    ds_read_u16 v24, v28 offset:1280
    ds_read_u16 v25, v28 offset:1312
    ds_read_u16 v26, v28 offset:1344
    ds_read_u16 v27, v28 offset:1376
    s_waitcnt lgkmcnt(4)
    v_lshlrev_b32 v16, 16, v16
    v_lshlrev_b32 v17, 16, v17
    v_lshlrev_b32 v18, 16, v18
    v_lshlrev_b32 v19, 16, v19
    v_lshlrev_b32 v20, 16, v20
    v_lshlrev_b32 v21, 16, v21
    v_lshlrev_b32 v22, 16, v22
    v_lshlrev_b32 v23, 16, v23
    v_mul_f32 v16, s98, v16
    v_mul_f32 v17, s98, v17
    v_mul_f32 v18, s98, v18
    v_mul_f32 v19, s98, v19
    v_mul_f32 v20, s98, v20
    v_mul_f32 v21, s98, v21
    v_mul_f32 v22, s98, v22
    v_mul_f32 v23, s98, v23
    v_fma_f32 v32, v64, s98, v16
    v_fma_f32 v40, v65, s98, v16
    v_fma_f32 v48, v66, s98, v16
    v_fma_f32 v56, v67, s98, v16
    v_fma_f32 v33, v68, s98, v17
    v_fma_f32 v41, v69, s98, v17
    v_fma_f32 v49, v70, s98, v17
    v_fma_f32 v57, v71, s98, v17
    v_fma_f32 v34, v72, s98, v18
    v_fma_f32 v42, v73, s98, v18
    v_fma_f32 v50, v74, s98, v18
    v_fma_f32 v58, v75, s98, v18
    v_fma_f32 v35, v76, s98, v19
    v_fma_f32 v43, v77, s98, v19
    v_fma_f32 v51, v78, s98, v19
    v_fma_f32 v59, v79, s98, v19
    v_fma_f32 v36, v80, s98, v20
    v_fma_f32 v44, v81, s98, v20
    v_fma_f32 v52, v82, s98, v20
    v_fma_f32 v60, v83, s98, v20
    v_fma_f32 v37, v84, s98, v21
    v_fma_f32 v45, v85, s98, v21
    v_fma_f32 v53, v86, s98, v21
    v_fma_f32 v61, v87, s98, v21
    v_fma_f32 v38, v88, s98, v22
    v_fma_f32 v46, v89, s98, v22
    v_fma_f32 v54, v90, s98, v22
    v_fma_f32 v62, v91, s98, v22
    v_fma_f32 v39, v92, s98, v23
    v_fma_f32 v47, v93, s98, v23
    v_fma_f32 v55, v94, s98, v23
    v_fma_f32 v63, v95, s98, v23
    v_fma_f32 v64, v96, s98, v16
    v_fma_f32 v72, v97, s98, v16
    v_fma_f32 v80, v98, s98, v16
    v_fma_f32 v88, v99, s98, v16
    v_fma_f32 v65, v100, s98, v17
    v_fma_f32 v73, v101, s98, v17
    v_fma_f32 v81, v102, s98, v17
    v_fma_f32 v89, v103, s98, v17
    v_fma_f32 v66, v104, s98, v18
    v_fma_f32 v74, v105, s98, v18
    v_fma_f32 v82, v106, s98, v18
    v_fma_f32 v90, v107, s98, v18
    v_fma_f32 v67, v108, s98, v19
    v_fma_f32 v75, v109, s98, v19
    v_fma_f32 v83, v110, s98, v19
    v_fma_f32 v91, v111, s98, v19
    v_fma_f32 v68, v112, s98, v20
    v_fma_f32 v76, v113, s98, v20
    v_fma_f32 v84, v114, s98, v20
    v_fma_f32 v92, v115, s98, v20
    v_fma_f32 v69, v116, s98, v21
    v_fma_f32 v77, v117, s98, v21
    v_fma_f32 v85, v118, s98, v21
    v_fma_f32 v93, v119, s98, v21
    v_fma_f32 v70, v120, s98, v22
    v_fma_f32 v78, v121, s98, v22
    v_fma_f32 v86, v122, s98, v22
    v_fma_f32 v94, v123, s98, v22
    v_fma_f32 v71, v124, s98, v23
    v_fma_f32 v79, v125, s98, v23
    v_fma_f32 v87, v126, s98, v23
    v_fma_f32 v95, v127, s98, v23
    s_waitcnt lgkmcnt(0)
    v_lshlrev_b32 v24, 16, v24
    v_lshlrev_b32 v25, 16, v25
    v_lshlrev_b32 v26, 16, v26
    v_lshlrev_b32 v27, 16, v27
    v_pk_mul_f32 v[24:25], s[98:99], v[24:25]
    v_pk_mul_f32 v[26:27], s[98:99], v[26:27]
    v_cvt_pk_bf16_f32 v6, v24, v25
    v_cvt_pk_bf16_f32 v7, v26, v27
    s_and_b32 s5, s3, 3
    s_cmp_eq_u32 s5, 3
    s_cselect_b64 exec, 0xffff, -1
    s_barrier
    ds_write_b128 v8, v[32:35] offset:0
    ds_write_b128 v9, v[36:39] offset:256
    ds_write_b128 v8, v[40:43] offset:1040
    ds_write_b128 v9, v[44:47] offset:1296
    s_cbranch_scc1 k1_q1
    ds_write_b128 v8, v[48:51] offset:2080
    ds_write_b128 v9, v[52:55] offset:2336
    ds_write_b128 v8, v[56:59] offset:3120
    ds_write_b128 v9, v[60:63] offset:3376
k1_q1:
    s_barrier
    s_cmp_lg_u32 s3, 15
    s_cbranch_scc1 k1_q3
    v_lshlrev_b32 v12, 7, v1
    s_mov_b64 exec, 65535
    global_load_dword v14, v12, s[80:81] sc1
k1_q3:
    s_mov_b64 exec, -1
    s_cmp_eq_u32 s5, 3
    s_cbranch_scc1 k1_q2
    ds_write_b128 v8, v[64:67] offset:16640
    ds_write_b128 v9, v[68:71] offset:16896
    ds_write_b128 v8, v[72:75] offset:17680
    ds_write_b128 v9, v[76:79] offset:17936
    ds_write_b128 v8, v[80:83] offset:18720
    ds_write_b128 v9, v[84:87] offset:18976
    ds_write_b128 v8, v[88:91] offset:19760
    ds_write_b128 v9, v[92:95] offset:20016
k1_q2:
    s_barrier
    s_and_b32 s5, s3, 7
    s_mov_b64 exec, -1
    s_lshl_b32 s6, s3, 6
    v_add_u32 v16, s6, v2
    s_lshl_b32 s6, s5, 3
    v_mov_b32 v17, s6
    ds_read_b32 v16, v16 offset:0
    ds_read_b64 v[18:19], v17 offset:2368
    s_mov_b32 s44, s32
    s_mov_b32 s45, s33
    s_mov_b32 s46, 12800000
    s_mov_b32 s47, 0x20000
    s_mov_b32 s74, 0xffffff00
    s_mov_b32 s75, 0xffffff00
    s_mov_b32 s82, 0x21800000
    s_mov_b32 s83, 0x21800000
    s_lshl_b32 s6, s3, 12
    s_add_u32 s86, s6, 16384
    s_add_u32 s6, s6, 33619968
    s_add_u32 s84, s32, s6
    s_addc_u32 s85, s33, 0
    v_and_b32 v60, 1, v1
    v_cmp_eq_u32 vcc, 0, v60
    v_mov_b32 v61, 0x01000c0c
    v_mov_b32 v62, 0x0c0c0100
    v_cndmask_b32 v61, v61, v62, vcc
    v_and_b32 v60, 2, v1
    v_cmp_eq_u32 vcc, 0, v60
    v_mov_b32 v62, 0x0c0c0c0c
    v_mov_b32 v63, 0x3f80
    v_cndmask_b32 v10, v62, v61, vcc
    v_cndmask_b32 v11, v61, v62, vcc
    v_perm_b32 v4, v63, v63, v10
    v_perm_b32 v5, v63, v63, v11
    s_waitcnt lgkmcnt(0)
    v_readlane_b32 s10, v16, 0
    v_readlane_b32 s11, v16, 1
    v_readlane_b32 s12, v16, 2
    v_readlane_b32 s13, v16, 3
    v_readlane_b32 s14, v16, 4
    v_readlane_b32 s15, v16, 5
    v_readlane_b32 s96, v16, 6
    v_readfirstlane_b32 s8, v18
    v_readfirstlane_b32 s7, v19
    v_and_b32 v99, 1, v1
    v_mul_u32_u24 v99, 0x180, v99
    v_and_b32 v98, 0xf0, v2
    v_xor_b32 v99, v99, v98
    v_and_b32 v98, 0x200, v3
    v_or_b32 v99, v99, v98
    s_min_u32 s5, s10, 97
    s_mul_i32 s5, s5, 1040
    v_add_u32 v92, s5, v99
    s_min_u32 s5, s11, 97
    s_mul_i32 s5, s5, 1040
    v_add_u32 v93, s5, v99
    s_min_u32 s5, s12, 97
    s_mul_i32 s5, s5, 1040
    v_add_u32 v94, s5, v99
    s_min_u32 s5, s13, 97
    s_mul_i32 s5, s5, 1040
    v_add_u32 v95, s5, v99
    s_min_u32 s5, s14, 97
    s_mul_i32 s5, s5, 1040
    v_add_u32 v96, s5, v99
    s_min_u32 s5, s15, 97
    s_mul_i32 s5, s5, 1040
    v_add_u32 v97, s5, v99
    s_min_u32 s5, s96, 97
    s_mul_i32 s5, s5, 1040
    v_add_u32 v98, s5, v99
    v_add_u32 v99, s8, v2
    v_lshrrev_b32 v13, 2, v1
    s_lshr_b32 s5, s8, 1
    v_lshl_add_u32 v13, v13, 1, s5
    s_cmp_lg_u32 s3, 15
    s_cbranch_scc1 k1_pok
    s_mov_b64 exec, 65535
    s_waitcnt vmcnt(0)
    v_cmp_ne_u32 vcc, 16, v14
    s_mov_b64 exec, -1
    s_cbranch_vccz k1_pok
    s_mov_b32 s77, 50000
    s_mov_b64 exec, 65535
k1_gp:
    global_load_dword v14, v12, s[80:81] offset:0 sc1
    s_sub_u32 s77, s77, 1
    s_cbranch_scc1 k1_gp_ok
    s_waitcnt vmcnt(0)
    v_cmp_ne_u32 vcc, 16, v14
    s_cbranch_vccz k1_gp_ok
    s_sleep 4
    s_branch k1_gp
k1_gp_ok:
    s_mov_b64 exec, -1
k1_pok:
    s_barrier
k2_join:
    s_setprio 3
    ds_read_b64 v[44:45], v99 offset:16128
    ds_read_u16 v24, v13 offset:7168
    ds_read_u16 v12, v13 offset:7192
    ds_read_b128 v[100:103], v92 offset:59648
    ds_read_b128 v[104:107], v93 offset:59648
    ds_read_b128 v[108:111], v94 offset:59648
    ds_read_b128 v[112:115], v95 offset:59648
    ds_read_b128 v[116:119], v96 offset:59648
    ds_read_b128 v[120:123], v97 offset:59648
    ds_read_b128 v[124:127], v98 offset:59648
    s_waitcnt lgkmcnt(9)
    buffer_store_dwordx2 v[44:45], v99, s[40:43], 0 offen
    v_readlane_b32 s48, v44, 0
    v_readlane_b32 s49, v45, 0
    v_readlane_b32 s50, v44, 1
    v_readlane_b32 s51, v45, 1
    v_readlane_b32 s52, v44, 2
    v_readlane_b32 s53, v45, 2
    v_readlane_b32 s54, v44, 3
    v_readlane_b32 s55, v45, 3
    s_and_b64 s[88:89], s[48:49], s[74:75]
    s_and_b64 s[90:91], s[50:51], s[74:75]
    s_and_b64 s[92:93], s[52:53], s[74:75]
    s_and_b64 s[94:95], s[54:55], s[74:75]
    buffer_load_dwordx2 v[28:29], v2, s[44:47], s88 offen sc1
    buffer_load_dwordx2 v[30:31], v2, s[44:47], s89 offen sc1
    buffer_load_dwordx2 v[32:33], v2, s[44:47], s90 offen sc1
    buffer_load_dwordx2 v[34:35], v2, s[44:47], s91 offen sc1
    buffer_load_dwordx2 v[36:37], v2, s[44:47], s92 offen sc1
    buffer_load_dwordx2 v[38:39], v2, s[44:47], s93 offen sc1
    buffer_load_dwordx2 v[40:41], v2, s[44:47], s94 offen sc1
    buffer_load_dwordx2 v[42:43], v2, s[44:47], s95 offen sc1
    s_add_u32 s5, s7, 64
    s_cmp_le_u32 s5, 512
    s_cbranch_scc1 k2_copied
k2_copy:
    v_add_u32 v99, 512, v99
    ds_read_b64 v[48:49], v99 offset:16128
    s_sub_u32 s5, s5, 512
    s_waitcnt lgkmcnt(0)
    buffer_store_dwordx2 v[48:49], v99, s[40:43], 0 offen
    s_cmp_gt_u32 s5, 512
    s_cbranch_scc1 k2_copy
k2_copied:
    v_mov_b32 v16, 1
    s_mov_b64 exec, 1
    ds_add_u32 v15, v16 offset:2968
    s_mov_b64 exec, -1
    v_readlane_b32 s56, v44, 4
    v_readlane_b32 s57, v45, 4
    v_readlane_b32 s58, v44, 5
    v_readlane_b32 s59, v45, 5
    v_readlane_b32 s60, v44, 6
    v_readlane_b32 s61, v45, 6
    v_readlane_b32 s62, v44, 7
    v_readlane_b32 s63, v45, 7
    v_readlane_b32 s64, v44, 8
    v_readlane_b32 s65, v45, 8
    v_readlane_b32 s66, v44, 9
    v_readlane_b32 s67, v45, 9
    v_readlane_b32 s68, v44, 10
    v_readlane_b32 s69, v45, 10
    v_readlane_b32 s70, v44, 11
    v_readlane_b32 s71, v45, 11
    s_waitcnt lgkmcnt(0)
    v_perm_b32 v8, v24, v24, v10
    v_perm_b32 v9, v24, v24, v11
    v_mov_b64 v[44:45], 0
    v_mov_b64 v[72:73], s[82:83]
    v_mov_b64 v[46:47], 0
    v_mov_b64 v[74:75], s[82:83]
    v_mov_b64 v[48:49], 0
    v_mov_b64 v[76:77], s[82:83]
    v_mov_b64 v[50:51], 0
    v_mov_b64 v[78:79], s[82:83]
    v_mov_b64 v[52:53], 0
    v_mov_b64 v[80:81], s[82:83]
    v_mov_b64 v[54:55], 0
    v_mov_b64 v[82:83], s[82:83]
    v_mov_b64 v[56:57], 0
    v_mov_b64 v[84:85], s[82:83]
    v_mov_b64 v[58:59], 0
    v_mov_b64 v[86:87], s[82:83]
    v_mov_b64 v[60:61], 0
    v_mov_b64 v[88:89], s[82:83]
    v_mov_b64 v[62:63], 0
    v_mov_b64 v[90:91], s[82:83]
    v_mov_b64 v[64:65], 0
    v_mov_b64 v[92:93], s[82:83]
    v_mov_b64 v[66:67], 0
    v_mov_b64 v[94:95], s[82:83]
    v_mov_b64 v[68:69], 0
    v_mov_b64 v[96:97], s[82:83]
    v_mov_b64 v[70:71], 0
    v_mov_b64 v[98:99], s[82:83]
    s_mov_b32 s76, s8
    s_add_u32 s8, s8, 96
    s_lshr_b32 s9, s7, 2
    s_and_b64 s[72:73], s[56:57], s[74:75]
    s_set_gpr_idx_on s48, gpr_idx(SRC2)
    v_mfma_f32_4x4x4_16b_bf16 v[16:19], v[8:9], v[6:7], v[100:103] cbsz:4 abid:0
    s_set_gpr_idx_off
    s_waitcnt vmcnt(7)
    v_mfma_f32_4x4x4_16b_bf16 v[16:19], v[4:5], v[28:29], v[16:19]
    buffer_load_dwordx2 v[28:29], v2, s[44:47], s72 offen sc1
    s_setprio 2
    s_waitcnt vmcnt(7)
    s_sub_u32 s9, s9, 8
    s_cbranch_scc1 k2_tail0
k2_loop:
    s_set_gpr_idx_on s49, gpr_idx(SRC2)
    v_mfma_f32_4x4x4_16b_bf16 v[20:23], v[8:9], v[6:7], v[100:103] cbsz:4 abid:1
    v_exp_f32 v24, v16
    v_exp_f32 v25, v17
    s_set_gpr_idx_off
    v_mfma_f32_4x4x4_16b_bf16 v[20:23], v[4:5], v[30:31], v[20:23]
    v_exp_f32 v26, v18
    v_exp_f32 v27, v19
    buffer_load_dwordx2 v[30:31], v2, s[44:47], s73 offen sc1
    s_set_gpr_idx_on s48, gpr_idx(SRC0,SRC2,DST)
    v_pk_fma_f32 v[44:45], v[44:45], v[24:25], v[44:45]
    v_pk_fma_f32 v[46:47], v[46:47], v[26:27], v[46:47]
    v_pk_fma_f32 v[44:45], v[72:73], v[16:17], v[44:45]
    v_pk_fma_f32 v[46:47], v[74:75], v[18:19], v[46:47]
    v_pk_fma_f32 v[72:73], v[72:73], v[24:25], v[72:73]
    v_pk_fma_f32 v[74:75], v[74:75], v[26:27], v[74:75]
    s_waitcnt vmcnt(7)
    s_and_b64 s[72:73], s[58:59], s[74:75]
    s_set_gpr_idx_on s50, gpr_idx(SRC2)
    v_mfma_f32_4x4x4_16b_bf16 v[16:19], v[8:9], v[6:7], v[100:103] cbsz:4 abid:2
    v_exp_f32 v24, v20
    v_exp_f32 v25, v21
    s_set_gpr_idx_off
    v_mfma_f32_4x4x4_16b_bf16 v[16:19], v[4:5], v[32:33], v[16:19]
    v_exp_f32 v26, v22
    v_exp_f32 v27, v23
    buffer_load_dwordx2 v[32:33], v2, s[44:47], s72 offen sc1
    s_set_gpr_idx_on s49, gpr_idx(SRC0,SRC2,DST)
    v_pk_fma_f32 v[44:45], v[44:45], v[24:25], v[44:45]
    v_pk_fma_f32 v[46:47], v[46:47], v[26:27], v[46:47]
    v_pk_fma_f32 v[44:45], v[72:73], v[20:21], v[44:45]
    v_pk_fma_f32 v[46:47], v[74:75], v[22:23], v[46:47]
    v_pk_fma_f32 v[72:73], v[72:73], v[24:25], v[72:73]
    v_pk_fma_f32 v[74:75], v[74:75], v[26:27], v[74:75]
    s_waitcnt vmcnt(7)
    s_set_gpr_idx_on s51, gpr_idx(SRC2)
    v_mfma_f32_4x4x4_16b_bf16 v[20:23], v[8:9], v[6:7], v[100:103] cbsz:4 abid:3
    v_exp_f32 v24, v16
    v_exp_f32 v25, v17
    s_set_gpr_idx_off
    v_mfma_f32_4x4x4_16b_bf16 v[20:23], v[4:5], v[34:35], v[20:23]
    v_exp_f32 v26, v18
    v_exp_f32 v27, v19
    buffer_load_dwordx2 v[34:35], v2, s[44:47], s73 offen sc1
    s_set_gpr_idx_on s50, gpr_idx(SRC0,SRC2,DST)
    v_pk_fma_f32 v[44:45], v[44:45], v[24:25], v[44:45]
    v_pk_fma_f32 v[46:47], v[46:47], v[26:27], v[46:47]
    v_pk_fma_f32 v[44:45], v[72:73], v[16:17], v[44:45]
    v_pk_fma_f32 v[46:47], v[74:75], v[18:19], v[46:47]
    v_pk_fma_f32 v[72:73], v[72:73], v[24:25], v[72:73]
    v_pk_fma_f32 v[74:75], v[74:75], v[26:27], v[74:75]
    s_waitcnt vmcnt(7)
    s_and_b64 s[72:73], s[60:61], s[74:75]
    s_set_gpr_idx_on s52, gpr_idx(SRC2)
    v_mfma_f32_4x4x4_16b_bf16 v[16:19], v[8:9], v[6:7], v[100:103] cbsz:4 abid:4
    v_exp_f32 v24, v20
    v_exp_f32 v25, v21
    s_set_gpr_idx_off
    v_mfma_f32_4x4x4_16b_bf16 v[16:19], v[4:5], v[36:37], v[16:19]
    v_exp_f32 v26, v22
    v_exp_f32 v27, v23
    buffer_load_dwordx2 v[36:37], v2, s[44:47], s72 offen sc1
    s_set_gpr_idx_on s51, gpr_idx(SRC0,SRC2,DST)
    v_pk_fma_f32 v[44:45], v[44:45], v[24:25], v[44:45]
    v_pk_fma_f32 v[46:47], v[46:47], v[26:27], v[46:47]
    v_pk_fma_f32 v[44:45], v[72:73], v[20:21], v[44:45]
    v_pk_fma_f32 v[46:47], v[74:75], v[22:23], v[46:47]
    v_pk_fma_f32 v[72:73], v[72:73], v[24:25], v[72:73]
    v_pk_fma_f32 v[74:75], v[74:75], v[26:27], v[74:75]
    s_waitcnt vmcnt(7)
    s_cmp_lt_u32 s72, 4807680
    s_cbranch_scc1 k2_pr0
    s_setprio 1
    s_cmp_lt_u32 s72, 9615360
    s_cbranch_scc1 k2_pr0
    s_setprio 0
k2_pr0:
    s_set_gpr_idx_on s53, gpr_idx(SRC2)
    v_mfma_f32_4x4x4_16b_bf16 v[20:23], v[8:9], v[6:7], v[100:103] cbsz:4 abid:5
    v_exp_f32 v24, v16
    v_exp_f32 v25, v17
    s_set_gpr_idx_off
    v_mfma_f32_4x4x4_16b_bf16 v[20:23], v[4:5], v[38:39], v[20:23]
    v_exp_f32 v26, v18
    v_exp_f32 v27, v19
    buffer_load_dwordx2 v[38:39], v2, s[44:47], s73 offen sc1
    s_set_gpr_idx_on s52, gpr_idx(SRC0,SRC2,DST)
    v_pk_fma_f32 v[44:45], v[44:45], v[24:25], v[44:45]
    v_pk_fma_f32 v[46:47], v[46:47], v[26:27], v[46:47]
    v_pk_fma_f32 v[44:45], v[72:73], v[16:17], v[44:45]
    v_pk_fma_f32 v[46:47], v[74:75], v[18:19], v[46:47]
    v_pk_fma_f32 v[72:73], v[72:73], v[24:25], v[72:73]
    v_pk_fma_f32 v[74:75], v[74:75], v[26:27], v[74:75]
    s_waitcnt vmcnt(7)
    s_and_b64 s[72:73], s[62:63], s[74:75]
    s_set_gpr_idx_on s54, gpr_idx(SRC2)
    v_mfma_f32_4x4x4_16b_bf16 v[16:19], v[8:9], v[6:7], v[100:103] cbsz:4 abid:6
    v_exp_f32 v24, v20
    v_exp_f32 v25, v21
    s_set_gpr_idx_off
    v_mfma_f32_4x4x4_16b_bf16 v[16:19], v[4:5], v[40:41], v[16:19]
    v_exp_f32 v26, v22
    v_exp_f32 v27, v23
    buffer_load_dwordx2 v[40:41], v2, s[44:47], s72 offen sc1
    s_set_gpr_idx_on s53, gpr_idx(SRC0,SRC2,DST)
    v_pk_fma_f32 v[44:45], v[44:45], v[24:25], v[44:45]
    v_pk_fma_f32 v[46:47], v[46:47], v[26:27], v[46:47]
    v_pk_fma_f32 v[44:45], v[72:73], v[20:21], v[44:45]
    v_pk_fma_f32 v[46:47], v[74:75], v[22:23], v[46:47]
    v_pk_fma_f32 v[72:73], v[72:73], v[24:25], v[72:73]
    v_pk_fma_f32 v[74:75], v[74:75], v[26:27], v[74:75]
    s_waitcnt vmcnt(7) lgkmcnt(0)
    s_set_gpr_idx_on s55, gpr_idx(SRC2)
    v_mfma_f32_4x4x4_16b_bf16 v[20:23], v[8:9], v[6:7], v[100:103] cbsz:4 abid:7
    v_exp_f32 v24, v16
    v_exp_f32 v25, v17
    s_set_gpr_idx_off
    v_mfma_f32_4x4x4_16b_bf16 v[20:23], v[4:5], v[42:43], v[20:23]
    v_exp_f32 v26, v18
    v_exp_f32 v27, v19
    buffer_load_dwordx2 v[42:43], v2, s[44:47], s73 offen sc1
    s_set_gpr_idx_on s54, gpr_idx(SRC0,SRC2,DST)
    v_pk_fma_f32 v[44:45], v[44:45], v[24:25], v[44:45]
    v_pk_fma_f32 v[46:47], v[46:47], v[26:27], v[46:47]
    v_pk_fma_f32 v[44:45], v[72:73], v[16:17], v[44:45]
    v_pk_fma_f32 v[46:47], v[74:75], v[18:19], v[46:47]
    v_pk_fma_f32 v[72:73], v[72:73], v[24:25], v[72:73]
    v_pk_fma_f32 v[74:75], v[74:75], v[26:27], v[74:75]
    s_waitcnt vmcnt(7)
    s_and_b64 s[72:73], s[64:65], s[74:75]
    s_set_gpr_idx_on s56, gpr_idx(SRC2)
    v_mfma_f32_4x4x4_16b_bf16 v[16:19], v[8:9], v[6:7], v[100:103] cbsz:4 abid:8
    v_exp_f32 v24, v20
    v_exp_f32 v25, v21
    s_set_gpr_idx_off
    v_mfma_f32_4x4x4_16b_bf16 v[16:19], v[4:5], v[28:29], v[16:19]
    v_exp_f32 v26, v22
    v_exp_f32 v27, v23
    buffer_load_dwordx2 v[28:29], v2, s[44:47], s72 offen sc1
    s_set_gpr_idx_on s55, gpr_idx(SRC0,SRC2,DST)
    v_pk_fma_f32 v[44:45], v[44:45], v[24:25], v[44:45]
    v_pk_fma_f32 v[46:47], v[46:47], v[26:27], v[46:47]
    v_pk_fma_f32 v[44:45], v[72:73], v[20:21], v[44:45]
    v_pk_fma_f32 v[46:47], v[74:75], v[22:23], v[46:47]
    v_pk_fma_f32 v[72:73], v[72:73], v[24:25], v[72:73]
    v_pk_fma_f32 v[74:75], v[74:75], v[26:27], v[74:75]
    s_waitcnt vmcnt(7)
    s_buffer_load_dwordx8 s[48:55], s[40:43], s8
    s_add_u32 s8, s8, 32
    s_sub_u32 s9, s9, 8
    s_cbranch_scc1 k2_tail1
    s_set_gpr_idx_on s57, gpr_idx(SRC2)
    v_mfma_f32_4x4x4_16b_bf16 v[20:23], v[8:9], v[6:7], v[100:103] cbsz:4 abid:9
    v_exp_f32 v24, v16
    v_exp_f32 v25, v17
    s_set_gpr_idx_off
    v_mfma_f32_4x4x4_16b_bf16 v[20:23], v[4:5], v[30:31], v[20:23]
    v_exp_f32 v26, v18
    v_exp_f32 v27, v19
    buffer_load_dwordx2 v[30:31], v2, s[44:47], s73 offen sc1
    s_set_gpr_idx_on s56, gpr_idx(SRC0,SRC2,DST)
    v_pk_fma_f32 v[44:45], v[44:45], v[24:25], v[44:45]
    v_pk_fma_f32 v[46:47], v[46:47], v[26:27], v[46:47]
    v_pk_fma_f32 v[44:45], v[72:73], v[16:17], v[44:45]
    v_pk_fma_f32 v[46:47], v[74:75], v[18:19], v[46:47]
    v_pk_fma_f32 v[72:73], v[72:73], v[24:25], v[72:73]
    v_pk_fma_f32 v[74:75], v[74:75], v[26:27], v[74:75]
    s_waitcnt vmcnt(7)
    s_and_b64 s[72:73], s[66:67], s[74:75]
    s_set_gpr_idx_on s58, gpr_idx(SRC2)
    v_mfma_f32_4x4x4_16b_bf16 v[16:19], v[8:9], v[6:7], v[100:103] cbsz:4 abid:10
    v_exp_f32 v24, v20
    v_exp_f32 v25, v21
    s_set_gpr_idx_off
    v_mfma_f32_4x4x4_16b_bf16 v[16:19], v[4:5], v[32:33], v[16:19]
    v_exp_f32 v26, v22
    v_exp_f32 v27, v23
    buffer_load_dwordx2 v[32:33], v2, s[44:47], s72 offen sc1
    s_set_gpr_idx_on s57, gpr_idx(SRC0,SRC2,DST)
    v_pk_fma_f32 v[44:45], v[44:45], v[24:25], v[44:45]
    v_pk_fma_f32 v[46:47], v[46:47], v[26:27], v[46:47]
    v_pk_fma_f32 v[44:45], v[72:73], v[20:21], v[44:45]
    v_pk_fma_f32 v[46:47], v[74:75], v[22:23], v[46:47]
    v_pk_fma_f32 v[72:73], v[72:73], v[24:25], v[72:73]
    v_pk_fma_f32 v[74:75], v[74:75], v[26:27], v[74:75]
    s_waitcnt vmcnt(7)
    s_set_gpr_idx_on s59, gpr_idx(SRC2)
    v_mfma_f32_4x4x4_16b_bf16 v[20:23], v[8:9], v[6:7], v[100:103] cbsz:4 abid:11
    v_exp_f32 v24, v16
    v_exp_f32 v25, v17
    s_set_gpr_idx_off
    v_mfma_f32_4x4x4_16b_bf16 v[20:23], v[4:5], v[34:35], v[20:23]
    v_exp_f32 v26, v18
    v_exp_f32 v27, v19
    v_perm_b32 v8, v12, v12, v10
    v_perm_b32 v9, v12, v12, v11
    buffer_load_dwordx2 v[34:35], v2, s[44:47], s73 offen sc1
    s_set_gpr_idx_on s58, gpr_idx(SRC0,SRC2,DST)
    v_pk_fma_f32 v[44:45], v[44:45], v[24:25], v[44:45]
    v_pk_fma_f32 v[46:47], v[46:47], v[26:27], v[46:47]
    v_pk_fma_f32 v[44:45], v[72:73], v[16:17], v[44:45]
    v_pk_fma_f32 v[46:47], v[74:75], v[18:19], v[46:47]
    v_pk_fma_f32 v[72:73], v[72:73], v[24:25], v[72:73]
    v_pk_fma_f32 v[74:75], v[74:75], v[26:27], v[74:75]
    s_waitcnt vmcnt(7)
    s_and_b64 s[72:73], s[68:69], s[74:75]
    s_set_gpr_idx_on s60, gpr_idx(SRC2)
    v_mfma_f32_4x4x4_16b_bf16 v[16:19], v[8:9], v[6:7], v[100:103] cbsz:4 abid:0
    v_exp_f32 v24, v20
    v_exp_f32 v25, v21
    s_set_gpr_idx_off
    v_mfma_f32_4x4x4_16b_bf16 v[16:19], v[4:5], v[36:37], v[16:19]
    v_exp_f32 v26, v22
    v_exp_f32 v27, v23
    buffer_load_dwordx2 v[36:37], v2, s[44:47], s72 offen sc1
    s_set_gpr_idx_on s59, gpr_idx(SRC0,SRC2,DST)
    v_pk_fma_f32 v[44:45], v[44:45], v[24:25], v[44:45]
    v_pk_fma_f32 v[46:47], v[46:47], v[26:27], v[46:47]
    v_pk_fma_f32 v[44:45], v[72:73], v[20:21], v[44:45]
    v_pk_fma_f32 v[46:47], v[74:75], v[22:23], v[46:47]
    v_pk_fma_f32 v[72:73], v[72:73], v[24:25], v[72:73]
    v_pk_fma_f32 v[74:75], v[74:75], v[26:27], v[74:75]
    s_waitcnt vmcnt(7)
    s_cmp_lt_u32 s72, 4807680
    s_cbranch_scc1 k2_pr1
    s_setprio 1
    s_cmp_lt_u32 s72, 9615360
    s_cbranch_scc1 k2_pr1
    s_setprio 0
k2_pr1:
    s_set_gpr_idx_on s61, gpr_idx(SRC2)
    v_mfma_f32_4x4x4_16b_bf16 v[20:23], v[8:9], v[6:7], v[100:103] cbsz:4 abid:1
    v_exp_f32 v24, v16
    v_exp_f32 v25, v17
    s_set_gpr_idx_off
    v_mfma_f32_4x4x4_16b_bf16 v[20:23], v[4:5], v[38:39], v[20:23]
    v_exp_f32 v26, v18
    v_exp_f32 v27, v19
    buffer_load_dwordx2 v[38:39], v2, s[44:47], s73 offen sc1
    s_set_gpr_idx_on s60, gpr_idx(SRC0,SRC2,DST)
    v_pk_fma_f32 v[44:45], v[44:45], v[24:25], v[44:45]
    v_pk_fma_f32 v[46:47], v[46:47], v[26:27], v[46:47]
    v_pk_fma_f32 v[44:45], v[72:73], v[16:17], v[44:45]
    v_pk_fma_f32 v[46:47], v[74:75], v[18:19], v[46:47]
    v_pk_fma_f32 v[72:73], v[72:73], v[24:25], v[72:73]
    v_pk_fma_f32 v[74:75], v[74:75], v[26:27], v[74:75]
    s_waitcnt vmcnt(7)
    s_and_b64 s[72:73], s[70:71], s[74:75]
    s_set_gpr_idx_on s62, gpr_idx(SRC2)
    v_mfma_f32_4x4x4_16b_bf16 v[16:19], v[8:9], v[6:7], v[100:103] cbsz:4 abid:2
    v_exp_f32 v24, v20
    v_exp_f32 v25, v21
    s_set_gpr_idx_off
    v_mfma_f32_4x4x4_16b_bf16 v[16:19], v[4:5], v[40:41], v[16:19]
    v_exp_f32 v26, v22
    v_exp_f32 v27, v23
    buffer_load_dwordx2 v[40:41], v2, s[44:47], s72 offen sc1
    s_set_gpr_idx_on s61, gpr_idx(SRC0,SRC2,DST)
    v_pk_fma_f32 v[44:45], v[44:45], v[24:25], v[44:45]
    v_pk_fma_f32 v[46:47], v[46:47], v[26:27], v[46:47]
    v_pk_fma_f32 v[44:45], v[72:73], v[20:21], v[44:45]
    v_pk_fma_f32 v[46:47], v[74:75], v[22:23], v[46:47]
    v_pk_fma_f32 v[72:73], v[72:73], v[24:25], v[72:73]
    v_pk_fma_f32 v[74:75], v[74:75], v[26:27], v[74:75]
    s_waitcnt vmcnt(7) lgkmcnt(0)
    s_set_gpr_idx_on s63, gpr_idx(SRC2)
    v_mfma_f32_4x4x4_16b_bf16 v[20:23], v[8:9], v[6:7], v[100:103] cbsz:4 abid:3
    v_exp_f32 v24, v16
    v_exp_f32 v25, v17
    s_set_gpr_idx_off
    v_mfma_f32_4x4x4_16b_bf16 v[20:23], v[4:5], v[42:43], v[20:23]
    v_exp_f32 v26, v18
    v_exp_f32 v27, v19
    v_add_u32 v13, 48, v13
    buffer_load_dwordx2 v[42:43], v2, s[44:47], s73 offen sc1
    s_set_gpr_idx_on s62, gpr_idx(SRC0,SRC2,DST)
    v_pk_fma_f32 v[44:45], v[44:45], v[24:25], v[44:45]
    v_pk_fma_f32 v[46:47], v[46:47], v[26:27], v[46:47]
    v_pk_fma_f32 v[44:45], v[72:73], v[16:17], v[44:45]
    v_pk_fma_f32 v[46:47], v[74:75], v[18:19], v[46:47]
    v_pk_fma_f32 v[72:73], v[72:73], v[24:25], v[72:73]
    v_pk_fma_f32 v[74:75], v[74:75], v[26:27], v[74:75]
    s_waitcnt vmcnt(7)
    s_and_b64 s[72:73], s[48:49], s[74:75]
    s_set_gpr_idx_on s64, gpr_idx(SRC2)
    v_mfma_f32_4x4x4_16b_bf16 v[16:19], v[8:9], v[6:7], v[100:103] cbsz:4 abid:4
    v_exp_f32 v24, v20
    v_exp_f32 v25, v21
    s_set_gpr_idx_off
    v_mfma_f32_4x4x4_16b_bf16 v[16:19], v[4:5], v[28:29], v[16:19]
    v_exp_f32 v26, v22
    v_exp_f32 v27, v23
    buffer_load_dwordx2 v[28:29], v2, s[44:47], s72 offen sc1
    s_set_gpr_idx_on s63, gpr_idx(SRC0,SRC2,DST)
    v_pk_fma_f32 v[44:45], v[44:45], v[24:25], v[44:45]
    v_pk_fma_f32 v[46:47], v[46:47], v[26:27], v[46:47]
    v_pk_fma_f32 v[44:45], v[72:73], v[20:21], v[44:45]
    v_pk_fma_f32 v[46:47], v[74:75], v[22:23], v[46:47]
    v_pk_fma_f32 v[72:73], v[72:73], v[24:25], v[72:73]
    v_pk_fma_f32 v[74:75], v[74:75], v[26:27], v[74:75]
    s_waitcnt vmcnt(7)
    s_buffer_load_dwordx8 s[56:63], s[40:43], s8
    s_add_u32 s8, s8, 32
    ds_read_u16 v12, v13 offset:7168
    s_sub_u32 s9, s9, 8
    s_cbranch_scc1 k2_tail2
    s_set_gpr_idx_on s65, gpr_idx(SRC2)
    v_mfma_f32_4x4x4_16b_bf16 v[20:23], v[8:9], v[6:7], v[100:103] cbsz:4 abid:5
    v_exp_f32 v24, v16
    v_exp_f32 v25, v17
    s_set_gpr_idx_off
    v_mfma_f32_4x4x4_16b_bf16 v[20:23], v[4:5], v[30:31], v[20:23]
    v_exp_f32 v26, v18
    v_exp_f32 v27, v19
    buffer_load_dwordx2 v[30:31], v2, s[44:47], s73 offen sc1
    s_set_gpr_idx_on s64, gpr_idx(SRC0,SRC2,DST)
    v_pk_fma_f32 v[44:45], v[44:45], v[24:25], v[44:45]
    v_pk_fma_f32 v[46:47], v[46:47], v[26:27], v[46:47]
    v_pk_fma_f32 v[44:45], v[72:73], v[16:17], v[44:45]
    v_pk_fma_f32 v[46:47], v[74:75], v[18:19], v[46:47]
    v_pk_fma_f32 v[72:73], v[72:73], v[24:25], v[72:73]
    v_pk_fma_f32 v[74:75], v[74:75], v[26:27], v[74:75]
    s_waitcnt vmcnt(7)
    s_and_b64 s[72:73], s[50:51], s[74:75]
    s_set_gpr_idx_on s66, gpr_idx(SRC2)
    v_mfma_f32_4x4x4_16b_bf16 v[16:19], v[8:9], v[6:7], v[100:103] cbsz:4 abid:6
    v_exp_f32 v24, v20
    v_exp_f32 v25, v21
    s_set_gpr_idx_off
    v_mfma_f32_4x4x4_16b_bf16 v[16:19], v[4:5], v[32:33], v[16:19]
    v_exp_f32 v26, v22
    v_exp_f32 v27, v23
    buffer_load_dwordx2 v[32:33], v2, s[44:47], s72 offen sc1
    s_set_gpr_idx_on s65, gpr_idx(SRC0,SRC2,DST)
    v_pk_fma_f32 v[44:45], v[44:45], v[24:25], v[44:45]
    v_pk_fma_f32 v[46:47], v[46:47], v[26:27], v[46:47]
    v_pk_fma_f32 v[44:45], v[72:73], v[20:21], v[44:45]
    v_pk_fma_f32 v[46:47], v[74:75], v[22:23], v[46:47]
    v_pk_fma_f32 v[72:73], v[72:73], v[24:25], v[72:73]
    v_pk_fma_f32 v[74:75], v[74:75], v[26:27], v[74:75]
    s_waitcnt vmcnt(7)
    s_set_gpr_idx_on s67, gpr_idx(SRC2)
    v_mfma_f32_4x4x4_16b_bf16 v[20:23], v[8:9], v[6:7], v[100:103] cbsz:4 abid:7
    v_exp_f32 v24, v16
    v_exp_f32 v25, v17
    s_set_gpr_idx_off
    v_mfma_f32_4x4x4_16b_bf16 v[20:23], v[4:5], v[34:35], v[20:23]
    v_exp_f32 v26, v18
    v_exp_f32 v27, v19
    buffer_load_dwordx2 v[34:35], v2, s[44:47], s73 offen sc1
    s_set_gpr_idx_on s66, gpr_idx(SRC0,SRC2,DST)
    v_pk_fma_f32 v[44:45], v[44:45], v[24:25], v[44:45]
    v_pk_fma_f32 v[46:47], v[46:47], v[26:27], v[46:47]
    v_pk_fma_f32 v[44:45], v[72:73], v[16:17], v[44:45]
    v_pk_fma_f32 v[46:47], v[74:75], v[18:19], v[46:47]
    v_pk_fma_f32 v[72:73], v[72:73], v[24:25], v[72:73]
    v_pk_fma_f32 v[74:75], v[74:75], v[26:27], v[74:75]
    s_waitcnt vmcnt(7)
    s_and_b64 s[72:73], s[52:53], s[74:75]
    s_set_gpr_idx_on s68, gpr_idx(SRC2)
    v_mfma_f32_4x4x4_16b_bf16 v[16:19], v[8:9], v[6:7], v[100:103] cbsz:4 abid:8
    v_exp_f32 v24, v20
    v_exp_f32 v25, v21
    s_set_gpr_idx_off
    v_mfma_f32_4x4x4_16b_bf16 v[16:19], v[4:5], v[36:37], v[16:19]
    v_exp_f32 v26, v22
    v_exp_f32 v27, v23
    buffer_load_dwordx2 v[36:37], v2, s[44:47], s72 offen sc1
    s_set_gpr_idx_on s67, gpr_idx(SRC0,SRC2,DST)
    v_pk_fma_f32 v[44:45], v[44:45], v[24:25], v[44:45]
    v_pk_fma_f32 v[46:47], v[46:47], v[26:27], v[46:47]
    v_pk_fma_f32 v[44:45], v[72:73], v[20:21], v[44:45]
    v_pk_fma_f32 v[46:47], v[74:75], v[22:23], v[46:47]
    v_pk_fma_f32 v[72:73], v[72:73], v[24:25], v[72:73]
    v_pk_fma_f32 v[74:75], v[74:75], v[26:27], v[74:75]
    s_waitcnt vmcnt(7)
    s_cmp_lt_u32 s72, 4807680
    s_cbranch_scc1 k2_pr2
    s_setprio 1
    s_cmp_lt_u32 s72, 9615360
    s_cbranch_scc1 k2_pr2
    s_setprio 0
k2_pr2:
    s_set_gpr_idx_on s69, gpr_idx(SRC2)
    v_mfma_f32_4x4x4_16b_bf16 v[20:23], v[8:9], v[6:7], v[100:103] cbsz:4 abid:9
    v_exp_f32 v24, v16
    v_exp_f32 v25, v17
    s_set_gpr_idx_off
    v_mfma_f32_4x4x4_16b_bf16 v[20:23], v[4:5], v[38:39], v[20:23]
    v_exp_f32 v26, v18
    v_exp_f32 v27, v19
    buffer_load_dwordx2 v[38:39], v2, s[44:47], s73 offen sc1
    s_set_gpr_idx_on s68, gpr_idx(SRC0,SRC2,DST)
    v_pk_fma_f32 v[44:45], v[44:45], v[24:25], v[44:45]
    v_pk_fma_f32 v[46:47], v[46:47], v[26:27], v[46:47]
    v_pk_fma_f32 v[44:45], v[72:73], v[16:17], v[44:45]
    v_pk_fma_f32 v[46:47], v[74:75], v[18:19], v[46:47]
    v_pk_fma_f32 v[72:73], v[72:73], v[24:25], v[72:73]
    v_pk_fma_f32 v[74:75], v[74:75], v[26:27], v[74:75]
    s_waitcnt vmcnt(7)
    s_and_b64 s[72:73], s[54:55], s[74:75]
    s_set_gpr_idx_on s70, gpr_idx(SRC2)
    v_mfma_f32_4x4x4_16b_bf16 v[16:19], v[8:9], v[6:7], v[100:103] cbsz:4 abid:10
    v_exp_f32 v24, v20
    v_exp_f32 v25, v21
    s_set_gpr_idx_off
    v_mfma_f32_4x4x4_16b_bf16 v[16:19], v[4:5], v[40:41], v[16:19]
    v_exp_f32 v26, v22
    v_exp_f32 v27, v23
    buffer_load_dwordx2 v[40:41], v2, s[44:47], s72 offen sc1
    s_set_gpr_idx_on s69, gpr_idx(SRC0,SRC2,DST)
    v_pk_fma_f32 v[44:45], v[44:45], v[24:25], v[44:45]
    v_pk_fma_f32 v[46:47], v[46:47], v[26:27], v[46:47]
    v_pk_fma_f32 v[44:45], v[72:73], v[20:21], v[44:45]
    v_pk_fma_f32 v[46:47], v[74:75], v[22:23], v[46:47]
    v_pk_fma_f32 v[72:73], v[72:73], v[24:25], v[72:73]
    v_pk_fma_f32 v[74:75], v[74:75], v[26:27], v[74:75]
    s_waitcnt vmcnt(7) lgkmcnt(0)
    s_set_gpr_idx_on s71, gpr_idx(SRC2)
    v_mfma_f32_4x4x4_16b_bf16 v[20:23], v[8:9], v[6:7], v[100:103] cbsz:4 abid:11
    v_exp_f32 v24, v16
    v_exp_f32 v25, v17
    s_set_gpr_idx_off
    v_mfma_f32_4x4x4_16b_bf16 v[20:23], v[4:5], v[42:43], v[20:23]
    v_exp_f32 v26, v18
    v_exp_f32 v27, v19
    v_perm_b32 v8, v12, v12, v10
    v_perm_b32 v9, v12, v12, v11
    buffer_load_dwordx2 v[42:43], v2, s[44:47], s73 offen sc1
    s_set_gpr_idx_on s70, gpr_idx(SRC0,SRC2,DST)
    v_pk_fma_f32 v[44:45], v[44:45], v[24:25], v[44:45]
    v_pk_fma_f32 v[46:47], v[46:47], v[26:27], v[46:47]
    v_pk_fma_f32 v[44:45], v[72:73], v[16:17], v[44:45]
    v_pk_fma_f32 v[46:47], v[74:75], v[18:19], v[46:47]
    v_pk_fma_f32 v[72:73], v[72:73], v[24:25], v[72:73]
    v_pk_fma_f32 v[74:75], v[74:75], v[26:27], v[74:75]
    s_waitcnt vmcnt(7)
    s_and_b64 s[72:73], s[56:57], s[74:75]
    s_set_gpr_idx_on s48, gpr_idx(SRC2)
    v_mfma_f32_4x4x4_16b_bf16 v[16:19], v[8:9], v[6:7], v[100:103] cbsz:4 abid:0
    v_exp_f32 v24, v20
    v_exp_f32 v25, v21
    s_set_gpr_idx_off
    v_mfma_f32_4x4x4_16b_bf16 v[16:19], v[4:5], v[28:29], v[16:19]
    v_exp_f32 v26, v22
    v_exp_f32 v27, v23
    buffer_load_dwordx2 v[28:29], v2, s[44:47], s72 offen sc1
    s_set_gpr_idx_on s71, gpr_idx(SRC0,SRC2,DST)
    v_pk_fma_f32 v[44:45], v[44:45], v[24:25], v[44:45]
    v_pk_fma_f32 v[46:47], v[46:47], v[26:27], v[46:47]
    v_pk_fma_f32 v[44:45], v[72:73], v[20:21], v[44:45]
    v_pk_fma_f32 v[46:47], v[74:75], v[22:23], v[46:47]
    v_pk_fma_f32 v[72:73], v[72:73], v[24:25], v[72:73]
    v_pk_fma_f32 v[74:75], v[74:75], v[26:27], v[74:75]
    s_waitcnt vmcnt(7)
    s_buffer_load_dwordx8 s[64:71], s[40:43], s8
    s_add_u32 s8, s8, 32
    ds_read_u16 v12, v13 offset:7192
    s_sub_u32 s9, s9, 8
    s_cbranch_scc0 k2_loop
k2_tail0:
    s_set_gpr_idx_off
    s_mov_b32 s77, 400000
k2_ps0:
    ds_read_b32 v14, v15 offset:2968
    s_sub_u32 s77, s77, 1
    s_cbranch_scc1 k2_ps0_ok
    s_waitcnt lgkmcnt(0)
    v_readfirstlane_b32 s5, v14
    s_and_b32 s5, s5, -1
    s_cmp_lg_u32 s5, 16
    s_cbranch_scc1 k2_ps0
k2_ps0_ok:
    s_mov_b32 m0, s86
    s_add_u32 s9, s9, 8
    global_load_lds_dwordx4 v3, s[84:85] offset:0 sc1
    global_load_lds_dwordx4 v3, s[84:85] offset:1024 sc1
    global_load_lds_dwordx4 v3, s[84:85] offset:2048 sc1
    global_load_lds_dwordx4 v3, s[84:85] offset:3072 sc1
    s_sub_u32 s9, s9, 1
    s_cbranch_scc1 k2_loopdone
    s_set_gpr_idx_on s49, gpr_idx(SRC2)
    v_mfma_f32_4x4x4_16b_bf16 v[20:23], v[8:9], v[6:7], v[100:103] cbsz:4 abid:1
    v_exp_f32 v24, v16
    v_exp_f32 v25, v17
    s_set_gpr_idx_off
    v_mfma_f32_4x4x4_16b_bf16 v[20:23], v[4:5], v[30:31], v[20:23]
    v_exp_f32 v26, v18
    v_exp_f32 v27, v19
    s_set_gpr_idx_on s48, gpr_idx(SRC0,SRC2,DST)
    v_pk_fma_f32 v[44:45], v[44:45], v[24:25], v[44:45]
    v_pk_fma_f32 v[46:47], v[46:47], v[26:27], v[46:47]
    v_pk_fma_f32 v[44:45], v[72:73], v[16:17], v[44:45]
    v_pk_fma_f32 v[46:47], v[74:75], v[18:19], v[46:47]
    v_pk_fma_f32 v[72:73], v[72:73], v[24:25], v[72:73]
    v_pk_fma_f32 v[74:75], v[74:75], v[26:27], v[74:75]
    s_waitcnt vmcnt(10)
    s_sub_u32 s9, s9, 1
    s_cbranch_scc1 k2_loopdone
    s_set_gpr_idx_on s50, gpr_idx(SRC2)
    v_mfma_f32_4x4x4_16b_bf16 v[16:19], v[8:9], v[6:7], v[100:103] cbsz:4 abid:2
    v_exp_f32 v24, v20
    v_exp_f32 v25, v21
    s_set_gpr_idx_off
    v_mfma_f32_4x4x4_16b_bf16 v[16:19], v[4:5], v[32:33], v[16:19]
    v_exp_f32 v26, v22
    v_exp_f32 v27, v23
    s_set_gpr_idx_on s49, gpr_idx(SRC0,SRC2,DST)
    v_pk_fma_f32 v[44:45], v[44:45], v[24:25], v[44:45]
    v_pk_fma_f32 v[46:47], v[46:47], v[26:27], v[46:47]
    v_pk_fma_f32 v[44:45], v[72:73], v[20:21], v[44:45]
    v_pk_fma_f32 v[46:47], v[74:75], v[22:23], v[46:47]
    v_pk_fma_f32 v[72:73], v[72:73], v[24:25], v[72:73]
    v_pk_fma_f32 v[74:75], v[74:75], v[26:27], v[74:75]
    s_waitcnt vmcnt(9)
    s_sub_u32 s9, s9, 1
    s_cbranch_scc1 k2_loopdone
    s_set_gpr_idx_on s51, gpr_idx(SRC2)
    v_mfma_f32_4x4x4_16b_bf16 v[20:23], v[8:9], v[6:7], v[100:103] cbsz:4 abid:3
    v_exp_f32 v24, v16
    v_exp_f32 v25, v17
    s_set_gpr_idx_off
    v_mfma_f32_4x4x4_16b_bf16 v[20:23], v[4:5], v[34:35], v[20:23]
    v_exp_f32 v26, v18
    v_exp_f32 v27, v19
    s_set_gpr_idx_on s50, gpr_idx(SRC0,SRC2,DST)
    v_pk_fma_f32 v[44:45], v[44:45], v[24:25], v[44:45]
    v_pk_fma_f32 v[46:47], v[46:47], v[26:27], v[46:47]
    v_pk_fma_f32 v[44:45], v[72:73], v[16:17], v[44:45]
    v_pk_fma_f32 v[46:47], v[74:75], v[18:19], v[46:47]
    v_pk_fma_f32 v[72:73], v[72:73], v[24:25], v[72:73]
    v_pk_fma_f32 v[74:75], v[74:75], v[26:27], v[74:75]
    s_waitcnt vmcnt(8)
    s_sub_u32 s9, s9, 1
    s_cbranch_scc1 k2_loopdone
    s_set_gpr_idx_on s52, gpr_idx(SRC2)
    v_mfma_f32_4x4x4_16b_bf16 v[16:19], v[8:9], v[6:7], v[100:103] cbsz:4 abid:4
    v_exp_f32 v24, v20
    v_exp_f32 v25, v21
    s_set_gpr_idx_off
    v_mfma_f32_4x4x4_16b_bf16 v[16:19], v[4:5], v[36:37], v[16:19]
    v_exp_f32 v26, v22
    v_exp_f32 v27, v23
    s_set_gpr_idx_on s51, gpr_idx(SRC0,SRC2,DST)
    v_pk_fma_f32 v[44:45], v[44:45], v[24:25], v[44:45]
    v_pk_fma_f32 v[46:47], v[46:47], v[26:27], v[46:47]
    v_pk_fma_f32 v[44:45], v[72:73], v[20:21], v[44:45]
    v_pk_fma_f32 v[46:47], v[74:75], v[22:23], v[46:47]
    v_pk_fma_f32 v[72:73], v[72:73], v[24:25], v[72:73]
    v_pk_fma_f32 v[74:75], v[74:75], v[26:27], v[74:75]
    s_waitcnt vmcnt(7)
    s_sub_u32 s9, s9, 1
    s_cbranch_scc1 k2_loopdone
    s_set_gpr_idx_on s53, gpr_idx(SRC2)
    v_mfma_f32_4x4x4_16b_bf16 v[20:23], v[8:9], v[6:7], v[100:103] cbsz:4 abid:5
    v_exp_f32 v24, v16
    v_exp_f32 v25, v17
    s_set_gpr_idx_off
    v_mfma_f32_4x4x4_16b_bf16 v[20:23], v[4:5], v[38:39], v[20:23]
    v_exp_f32 v26, v18
    v_exp_f32 v27, v19
    s_set_gpr_idx_on s52, gpr_idx(SRC0,SRC2,DST)
    v_pk_fma_f32 v[44:45], v[44:45], v[24:25], v[44:45]
    v_pk_fma_f32 v[46:47], v[46:47], v[26:27], v[46:47]
    v_pk_fma_f32 v[44:45], v[72:73], v[16:17], v[44:45]
    v_pk_fma_f32 v[46:47], v[74:75], v[18:19], v[46:47]
    v_pk_fma_f32 v[72:73], v[72:73], v[24:25], v[72:73]
    v_pk_fma_f32 v[74:75], v[74:75], v[26:27], v[74:75]
    s_waitcnt vmcnt(6)
    s_sub_u32 s9, s9, 1
    s_cbranch_scc1 k2_loopdone
    s_set_gpr_idx_on s54, gpr_idx(SRC2)
    v_mfma_f32_4x4x4_16b_bf16 v[16:19], v[8:9], v[6:7], v[100:103] cbsz:4 abid:6
    v_exp_f32 v24, v20
    v_exp_f32 v25, v21
    s_set_gpr_idx_off
    v_mfma_f32_4x4x4_16b_bf16 v[16:19], v[4:5], v[40:41], v[16:19]
    v_exp_f32 v26, v22
    v_exp_f32 v27, v23
    s_set_gpr_idx_on s53, gpr_idx(SRC0,SRC2,DST)
    v_pk_fma_f32 v[44:45], v[44:45], v[24:25], v[44:45]
    v_pk_fma_f32 v[46:47], v[46:47], v[26:27], v[46:47]
    v_pk_fma_f32 v[44:45], v[72:73], v[20:21], v[44:45]
    v_pk_fma_f32 v[46:47], v[74:75], v[22:23], v[46:47]
    v_pk_fma_f32 v[72:73], v[72:73], v[24:25], v[72:73]
    v_pk_fma_f32 v[74:75], v[74:75], v[26:27], v[74:75]
    s_waitcnt vmcnt(5) lgkmcnt(0)
    s_sub_u32 s9, s9, 1
    s_cbranch_scc1 k2_loopdone
    s_set_gpr_idx_on s55, gpr_idx(SRC2)
    v_mfma_f32_4x4x4_16b_bf16 v[20:23], v[8:9], v[6:7], v[100:103] cbsz:4 abid:7
    v_exp_f32 v24, v16
    v_exp_f32 v25, v17
    s_set_gpr_idx_off
    v_mfma_f32_4x4x4_16b_bf16 v[20:23], v[4:5], v[42:43], v[20:23]
    v_exp_f32 v26, v18
    v_exp_f32 v27, v19
    s_set_gpr_idx_on s54, gpr_idx(SRC0,SRC2,DST)
    v_pk_fma_f32 v[44:45], v[44:45], v[24:25], v[44:45]
    v_pk_fma_f32 v[46:47], v[46:47], v[26:27], v[46:47]
    v_pk_fma_f32 v[44:45], v[72:73], v[16:17], v[44:45]
    v_pk_fma_f32 v[46:47], v[74:75], v[18:19], v[46:47]
    v_pk_fma_f32 v[72:73], v[72:73], v[24:25], v[72:73]
    v_pk_fma_f32 v[74:75], v[74:75], v[26:27], v[74:75]
    s_waitcnt vmcnt(4)
    s_branch k2_loopdone
k2_tail1:
    s_set_gpr_idx_off
    s_mov_b32 s77, 400000
k2_ps1:
    ds_read_b32 v14, v15 offset:2968
    s_sub_u32 s77, s77, 1
    s_cbranch_scc1 k2_ps1_ok
    s_waitcnt lgkmcnt(0)
    v_readfirstlane_b32 s5, v14
    s_and_b32 s5, s5, -1
    s_cmp_lg_u32 s5, 16
    s_cbranch_scc1 k2_ps1
k2_ps1_ok:
    s_mov_b32 m0, s86
    s_add_u32 s9, s9, 8
    global_load_lds_dwordx4 v3, s[84:85] offset:0 sc1
    global_load_lds_dwordx4 v3, s[84:85] offset:1024 sc1
    global_load_lds_dwordx4 v3, s[84:85] offset:2048 sc1
    global_load_lds_dwordx4 v3, s[84:85] offset:3072 sc1
    s_sub_u32 s9, s9, 1
    s_cbranch_scc1 k2_loopdone
    s_set_gpr_idx_on s57, gpr_idx(SRC2)
    v_mfma_f32_4x4x4_16b_bf16 v[20:23], v[8:9], v[6:7], v[100:103] cbsz:4 abid:9
    v_exp_f32 v24, v16
    v_exp_f32 v25, v17
    s_set_gpr_idx_off
    v_mfma_f32_4x4x4_16b_bf16 v[20:23], v[4:5], v[30:31], v[20:23]
    v_exp_f32 v26, v18
    v_exp_f32 v27, v19
    s_set_gpr_idx_on s56, gpr_idx(SRC0,SRC2,DST)
    v_pk_fma_f32 v[44:45], v[44:45], v[24:25], v[44:45]
    v_pk_fma_f32 v[46:47], v[46:47], v[26:27], v[46:47]
    v_pk_fma_f32 v[44:45], v[72:73], v[16:17], v[44:45]
    v_pk_fma_f32 v[46:47], v[74:75], v[18:19], v[46:47]
    v_pk_fma_f32 v[72:73], v[72:73], v[24:25], v[72:73]
    v_pk_fma_f32 v[74:75], v[74:75], v[26:27], v[74:75]
    s_waitcnt vmcnt(10)
    s_sub_u32 s9, s9, 1
    s_cbranch_scc1 k2_loopdone
    s_set_gpr_idx_on s58, gpr_idx(SRC2)
    v_mfma_f32_4x4x4_16b_bf16 v[16:19], v[8:9], v[6:7], v[100:103] cbsz:4 abid:10
    v_exp_f32 v24, v20
    v_exp_f32 v25, v21
    s_set_gpr_idx_off
    v_mfma_f32_4x4x4_16b_bf16 v[16:19], v[4:5], v[32:33], v[16:19]
    v_exp_f32 v26, v22
    v_exp_f32 v27, v23
    s_set_gpr_idx_on s57, gpr_idx(SRC0,SRC2,DST)
    v_pk_fma_f32 v[44:45], v[44:45], v[24:25], v[44:45]
    v_pk_fma_f32 v[46:47], v[46:47], v[26:27], v[46:47]
    v_pk_fma_f32 v[44:45], v[72:73], v[20:21], v[44:45]
    v_pk_fma_f32 v[46:47], v[74:75], v[22:23], v[46:47]
    v_pk_fma_f32 v[72:73], v[72:73], v[24:25], v[72:73]
    v_pk_fma_f32 v[74:75], v[74:75], v[26:27], v[74:75]
    s_waitcnt vmcnt(9)
    s_sub_u32 s9, s9, 1
    s_cbranch_scc1 k2_loopdone
    s_set_gpr_idx_on s59, gpr_idx(SRC2)
    v_mfma_f32_4x4x4_16b_bf16 v[20:23], v[8:9], v[6:7], v[100:103] cbsz:4 abid:11
    v_exp_f32 v24, v16
    v_exp_f32 v25, v17
    s_set_gpr_idx_off
    v_mfma_f32_4x4x4_16b_bf16 v[20:23], v[4:5], v[34:35], v[20:23]
    v_exp_f32 v26, v18
    v_exp_f32 v27, v19
    v_perm_b32 v8, v12, v12, v10
    v_perm_b32 v9, v12, v12, v11
    s_set_gpr_idx_on s58, gpr_idx(SRC0,SRC2,DST)
    v_pk_fma_f32 v[44:45], v[44:45], v[24:25], v[44:45]
    v_pk_fma_f32 v[46:47], v[46:47], v[26:27], v[46:47]
    v_pk_fma_f32 v[44:45], v[72:73], v[16:17], v[44:45]
    v_pk_fma_f32 v[46:47], v[74:75], v[18:19], v[46:47]
    v_pk_fma_f32 v[72:73], v[72:73], v[24:25], v[72:73]
    v_pk_fma_f32 v[74:75], v[74:75], v[26:27], v[74:75]
    s_waitcnt vmcnt(8)
    s_sub_u32 s9, s9, 1
    s_cbranch_scc1 k2_loopdone
    s_set_gpr_idx_on s60, gpr_idx(SRC2)
    v_mfma_f32_4x4x4_16b_bf16 v[16:19], v[8:9], v[6:7], v[100:103] cbsz:4 abid:0
    v_exp_f32 v24, v20
    v_exp_f32 v25, v21
    s_set_gpr_idx_off
    v_mfma_f32_4x4x4_16b_bf16 v[16:19], v[4:5], v[36:37], v[16:19]
    v_exp_f32 v26, v22
    v_exp_f32 v27, v23
    s_set_gpr_idx_on s59, gpr_idx(SRC0,SRC2,DST)
    v_pk_fma_f32 v[44:45], v[44:45], v[24:25], v[44:45]
    v_pk_fma_f32 v[46:47], v[46:47], v[26:27], v[46:47]
    v_pk_fma_f32 v[44:45], v[72:73], v[20:21], v[44:45]
    v_pk_fma_f32 v[46:47], v[74:75], v[22:23], v[46:47]
    v_pk_fma_f32 v[72:73], v[72:73], v[24:25], v[72:73]
    v_pk_fma_f32 v[74:75], v[74:75], v[26:27], v[74:75]
    s_waitcnt vmcnt(7)
    s_sub_u32 s9, s9, 1
    s_cbranch_scc1 k2_loopdone
    s_set_gpr_idx_on s61, gpr_idx(SRC2)
    v_mfma_f32_4x4x4_16b_bf16 v[20:23], v[8:9], v[6:7], v[100:103] cbsz:4 abid:1
    v_exp_f32 v24, v16
    v_exp_f32 v25, v17
    s_set_gpr_idx_off
    v_mfma_f32_4x4x4_16b_bf16 v[20:23], v[4:5], v[38:39], v[20:23]
    v_exp_f32 v26, v18
    v_exp_f32 v27, v19
    s_set_gpr_idx_on s60, gpr_idx(SRC0,SRC2,DST)
    v_pk_fma_f32 v[44:45], v[44:45], v[24:25], v[44:45]
    v_pk_fma_f32 v[46:47], v[46:47], v[26:27], v[46:47]
    v_pk_fma_f32 v[44:45], v[72:73], v[16:17], v[44:45]
    v_pk_fma_f32 v[46:47], v[74:75], v[18:19], v[46:47]
    v_pk_fma_f32 v[72:73], v[72:73], v[24:25], v[72:73]
    v_pk_fma_f32 v[74:75], v[74:75], v[26:27], v[74:75]
    s_waitcnt vmcnt(6)
    s_sub_u32 s9, s9, 1
    s_cbranch_scc1 k2_loopdone
    s_set_gpr_idx_on s62, gpr_idx(SRC2)
    v_mfma_f32_4x4x4_16b_bf16 v[16:19], v[8:9], v[6:7], v[100:103] cbsz:4 abid:2
    v_exp_f32 v24, v20
    v_exp_f32 v25, v21
    s_set_gpr_idx_off
    v_mfma_f32_4x4x4_16b_bf16 v[16:19], v[4:5], v[40:41], v[16:19]
    v_exp_f32 v26, v22
    v_exp_f32 v27, v23
    s_set_gpr_idx_on s61, gpr_idx(SRC0,SRC2,DST)
    v_pk_fma_f32 v[44:45], v[44:45], v[24:25], v[44:45]
    v_pk_fma_f32 v[46:47], v[46:47], v[26:27], v[46:47]
    v_pk_fma_f32 v[44:45], v[72:73], v[20:21], v[44:45]
    v_pk_fma_f32 v[46:47], v[74:75], v[22:23], v[46:47]
    v_pk_fma_f32 v[72:73], v[72:73], v[24:25], v[72:73]
    v_pk_fma_f32 v[74:75], v[74:75], v[26:27], v[74:75]
    s_waitcnt vmcnt(5) lgkmcnt(0)
    s_sub_u32 s9, s9, 1
    s_cbranch_scc1 k2_loopdone
    s_set_gpr_idx_on s63, gpr_idx(SRC2)
    v_mfma_f32_4x4x4_16b_bf16 v[20:23], v[8:9], v[6:7], v[100:103] cbsz:4 abid:3
    v_exp_f32 v24, v16
    v_exp_f32 v25, v17
    s_set_gpr_idx_off
    v_mfma_f32_4x4x4_16b_bf16 v[20:23], v[4:5], v[42:43], v[20:23]
    v_exp_f32 v26, v18
    v_exp_f32 v27, v19
    s_set_gpr_idx_on s62, gpr_idx(SRC0,SRC2,DST)
    v_pk_fma_f32 v[44:45], v[44:45], v[24:25], v[44:45]
    v_pk_fma_f32 v[46:47], v[46:47], v[26:27], v[46:47]
    v_pk_fma_f32 v[44:45], v[72:73], v[16:17], v[44:45]
    v_pk_fma_f32 v[46:47], v[74:75], v[18:19], v[46:47]
    v_pk_fma_f32 v[72:73], v[72:73], v[24:25], v[72:73]
    v_pk_fma_f32 v[74:75], v[74:75], v[26:27], v[74:75]
    s_waitcnt vmcnt(4)
    s_branch k2_loopdone
k2_tail2:
    s_set_gpr_idx_off
    s_mov_b32 s77, 400000
k2_ps2:
    ds_read_b32 v14, v15 offset:2968
    s_sub_u32 s77, s77, 1
    s_cbranch_scc1 k2_ps2_ok
    s_waitcnt lgkmcnt(0)
    v_readfirstlane_b32 s5, v14
    s_and_b32 s5, s5, -1
    s_cmp_lg_u32 s5, 16
    s_cbranch_scc1 k2_ps2
k2_ps2_ok:
    s_mov_b32 m0, s86
    s_add_u32 s9, s9, 8
    global_load_lds_dwordx4 v3, s[84:85] offset:0 sc1
    global_load_lds_dwordx4 v3, s[84:85] offset:1024 sc1
    global_load_lds_dwordx4 v3, s[84:85] offset:2048 sc1
    global_load_lds_dwordx4 v3, s[84:85] offset:3072 sc1
    s_sub_u32 s9, s9, 1
    s_cbranch_scc1 k2_loopdone
    s_set_gpr_idx_on s65, gpr_idx(SRC2)
    v_mfma_f32_4x4x4_16b_bf16 v[20:23], v[8:9], v[6:7], v[100:103] cbsz:4 abid:5
    v_exp_f32 v24, v16
    v_exp_f32 v25, v17
    s_set_gpr_idx_off
    v_mfma_f32_4x4x4_16b_bf16 v[20:23], v[4:5], v[30:31], v[20:23]
    v_exp_f32 v26, v18
    v_exp_f32 v27, v19
    s_set_gpr_idx_on s64, gpr_idx(SRC0,SRC2,DST)
    v_pk_fma_f32 v[44:45], v[44:45], v[24:25], v[44:45]
    v_pk_fma_f32 v[46:47], v[46:47], v[26:27], v[46:47]
    v_pk_fma_f32 v[44:45], v[72:73], v[16:17], v[44:45]
    v_pk_fma_f32 v[46:47], v[74:75], v[18:19], v[46:47]
    v_pk_fma_f32 v[72:73], v[72:73], v[24:25], v[72:73]
    v_pk_fma_f32 v[74:75], v[74:75], v[26:27], v[74:75]
    s_waitcnt vmcnt(10)
    s_sub_u32 s9, s9, 1
    s_cbranch_scc1 k2_loopdone
    s_set_gpr_idx_on s66, gpr_idx(SRC2)
    v_mfma_f32_4x4x4_16b_bf16 v[16:19], v[8:9], v[6:7], v[100:103] cbsz:4 abid:6
    v_exp_f32 v24, v20
    v_exp_f32 v25, v21
    s_set_gpr_idx_off
    v_mfma_f32_4x4x4_16b_bf16 v[16:19], v[4:5], v[32:33], v[16:19]
    v_exp_f32 v26, v22
    v_exp_f32 v27, v23
    s_set_gpr_idx_on s65, gpr_idx(SRC0,SRC2,DST)
    v_pk_fma_f32 v[44:45], v[44:45], v[24:25], v[44:45]
    v_pk_fma_f32 v[46:47], v[46:47], v[26:27], v[46:47]
    v_pk_fma_f32 v[44:45], v[72:73], v[20:21], v[44:45]
    v_pk_fma_f32 v[46:47], v[74:75], v[22:23], v[46:47]
    v_pk_fma_f32 v[72:73], v[72:73], v[24:25], v[72:73]
    v_pk_fma_f32 v[74:75], v[74:75], v[26:27], v[74:75]
    s_waitcnt vmcnt(9)
    s_sub_u32 s9, s9, 1
    s_cbranch_scc1 k2_loopdone
    s_set_gpr_idx_on s67, gpr_idx(SRC2)
    v_mfma_f32_4x4x4_16b_bf16 v[20:23], v[8:9], v[6:7], v[100:103] cbsz:4 abid:7
    v_exp_f32 v24, v16
    v_exp_f32 v25, v17
    s_set_gpr_idx_off
    v_mfma_f32_4x4x4_16b_bf16 v[20:23], v[4:5], v[34:35], v[20:23]
    v_exp_f32 v26, v18
    v_exp_f32 v27, v19
    s_set_gpr_idx_on s66, gpr_idx(SRC0,SRC2,DST)
    v_pk_fma_f32 v[44:45], v[44:45], v[24:25], v[44:45]
    v_pk_fma_f32 v[46:47], v[46:47], v[26:27], v[46:47]
    v_pk_fma_f32 v[44:45], v[72:73], v[16:17], v[44:45]
    v_pk_fma_f32 v[46:47], v[74:75], v[18:19], v[46:47]
    v_pk_fma_f32 v[72:73], v[72:73], v[24:25], v[72:73]
    v_pk_fma_f32 v[74:75], v[74:75], v[26:27], v[74:75]
    s_waitcnt vmcnt(8)
    s_sub_u32 s9, s9, 1
    s_cbranch_scc1 k2_loopdone
    s_set_gpr_idx_on s68, gpr_idx(SRC2)
    v_mfma_f32_4x4x4_16b_bf16 v[16:19], v[8:9], v[6:7], v[100:103] cbsz:4 abid:8
    v_exp_f32 v24, v20
    v_exp_f32 v25, v21
    s_set_gpr_idx_off
    v_mfma_f32_4x4x4_16b_bf16 v[16:19], v[4:5], v[36:37], v[16:19]
    v_exp_f32 v26, v22
    v_exp_f32 v27, v23
    s_set_gpr_idx_on s67, gpr_idx(SRC0,SRC2,DST)
    v_pk_fma_f32 v[44:45], v[44:45], v[24:25], v[44:45]
    v_pk_fma_f32 v[46:47], v[46:47], v[26:27], v[46:47]
    v_pk_fma_f32 v[44:45], v[72:73], v[20:21], v[44:45]
    v_pk_fma_f32 v[46:47], v[74:75], v[22:23], v[46:47]
    v_pk_fma_f32 v[72:73], v[72:73], v[24:25], v[72:73]
    v_pk_fma_f32 v[74:75], v[74:75], v[26:27], v[74:75]
    s_waitcnt vmcnt(7)
    s_sub_u32 s9, s9, 1
    s_cbranch_scc1 k2_loopdone
    s_set_gpr_idx_on s69, gpr_idx(SRC2)
    v_mfma_f32_4x4x4_16b_bf16 v[20:23], v[8:9], v[6:7], v[100:103] cbsz:4 abid:9
    v_exp_f32 v24, v16
    v_exp_f32 v25, v17
    s_set_gpr_idx_off
    v_mfma_f32_4x4x4_16b_bf16 v[20:23], v[4:5], v[38:39], v[20:23]
    v_exp_f32 v26, v18
    v_exp_f32 v27, v19
    s_set_gpr_idx_on s68, gpr_idx(SRC0,SRC2,DST)
    v_pk_fma_f32 v[44:45], v[44:45], v[24:25], v[44:45]
    v_pk_fma_f32 v[46:47], v[46:47], v[26:27], v[46:47]
    v_pk_fma_f32 v[44:45], v[72:73], v[16:17], v[44:45]
    v_pk_fma_f32 v[46:47], v[74:75], v[18:19], v[46:47]
    v_pk_fma_f32 v[72:73], v[72:73], v[24:25], v[72:73]
    v_pk_fma_f32 v[74:75], v[74:75], v[26:27], v[74:75]
    s_waitcnt vmcnt(6)
    s_sub_u32 s9, s9, 1
    s_cbranch_scc1 k2_loopdone
    s_set_gpr_idx_on s70, gpr_idx(SRC2)
    v_mfma_f32_4x4x4_16b_bf16 v[16:19], v[8:9], v[6:7], v[100:103] cbsz:4 abid:10
    v_exp_f32 v24, v20
    v_exp_f32 v25, v21
    s_set_gpr_idx_off
    v_mfma_f32_4x4x4_16b_bf16 v[16:19], v[4:5], v[40:41], v[16:19]
    v_exp_f32 v26, v22
    v_exp_f32 v27, v23
    s_set_gpr_idx_on s69, gpr_idx(SRC0,SRC2,DST)
    v_pk_fma_f32 v[44:45], v[44:45], v[24:25], v[44:45]
    v_pk_fma_f32 v[46:47], v[46:47], v[26:27], v[46:47]
    v_pk_fma_f32 v[44:45], v[72:73], v[20:21], v[44:45]
    v_pk_fma_f32 v[46:47], v[74:75], v[22:23], v[46:47]
    v_pk_fma_f32 v[72:73], v[72:73], v[24:25], v[72:73]
    v_pk_fma_f32 v[74:75], v[74:75], v[26:27], v[74:75]
    s_waitcnt vmcnt(5) lgkmcnt(0)
    s_sub_u32 s9, s9, 1
    s_cbranch_scc1 k2_loopdone
    s_set_gpr_idx_on s71, gpr_idx(SRC2)
    v_mfma_f32_4x4x4_16b_bf16 v[20:23], v[8:9], v[6:7], v[100:103] cbsz:4 abid:11
    v_exp_f32 v24, v16
    v_exp_f32 v25, v17
    s_set_gpr_idx_off
    v_mfma_f32_4x4x4_16b_bf16 v[20:23], v[4:5], v[42:43], v[20:23]
    v_exp_f32 v26, v18
    v_exp_f32 v27, v19
    v_perm_b32 v8, v12, v12, v10
    v_perm_b32 v9, v12, v12, v11
    s_set_gpr_idx_on s70, gpr_idx(SRC0,SRC2,DST)
    v_pk_fma_f32 v[44:45], v[44:45], v[24:25], v[44:45]
    v_pk_fma_f32 v[46:47], v[46:47], v[26:27], v[46:47]
    v_pk_fma_f32 v[44:45], v[72:73], v[16:17], v[44:45]
    v_pk_fma_f32 v[46:47], v[74:75], v[18:19], v[46:47]
    v_pk_fma_f32 v[72:73], v[72:73], v[24:25], v[72:73]
    v_pk_fma_f32 v[74:75], v[74:75], v[26:27], v[74:75]
    s_waitcnt vmcnt(4)
k2_loopdone:
    s_set_gpr_idx_off
    s_setprio 0
    v_mov_b32 v16, 0
    ds_read_b128 v[24:27], v16 offset:2304
    v_pk_mul_f32 v[18:19], v[44:45], v[72:73]
    v_pk_fma_f32 v[18:19], v[46:47], v[74:75], v[18:19]
    v_pk_fma_f32 v[18:19], v[48:49], v[76:77], v[18:19]
    v_pk_fma_f32 v[18:19], v[50:51], v[78:79], v[18:19]
    v_pk_fma_f32 v[18:19], v[52:53], v[80:81], v[18:19]
    v_pk_fma_f32 v[18:19], v[54:55], v[82:83], v[18:19]
    v_pk_fma_f32 v[18:19], v[56:57], v[84:85], v[18:19]
    v_pk_fma_f32 v[18:19], v[58:59], v[86:87], v[18:19]
    v_pk_fma_f32 v[18:19], v[60:61], v[88:89], v[18:19]
    v_pk_fma_f32 v[18:19], v[62:63], v[90:91], v[18:19]
    v_pk_fma_f32 v[18:19], v[64:65], v[92:93], v[18:19]
    v_pk_fma_f32 v[18:19], v[66:67], v[94:95], v[18:19]
    v_pk_fma_f32 v[18:19], v[68:69], v[96:97], v[18:19]
    v_pk_fma_f32 v[18:19], v[70:71], v[98:99], v[18:19]
    v_rcp_f32 v72, v72
    v_rcp_f32 v73, v73
    v_rcp_f32 v74, v74
    v_rcp_f32 v75, v75
    v_rcp_f32 v76, v76
    v_rcp_f32 v77, v77
    v_rcp_f32 v78, v78
    v_rcp_f32 v79, v79
    v_rcp_f32 v80, v80
    v_rcp_f32 v81, v81
    v_rcp_f32 v82, v82
    v_rcp_f32 v83, v83
    v_rcp_f32 v84, v84
    v_rcp_f32 v85, v85
    v_rcp_f32 v86, v86
    v_rcp_f32 v87, v87
    v_rcp_f32 v88, v88
    v_rcp_f32 v89, v89
    v_rcp_f32 v90, v90
    v_rcp_f32 v91, v91
    v_rcp_f32 v92, v92
    v_rcp_f32 v93, v93
    v_rcp_f32 v94, v94
    v_rcp_f32 v95, v95
    v_rcp_f32 v96, v96
    v_rcp_f32 v97, v97
    v_rcp_f32 v98, v98
    v_rcp_f32 v99, v99
    v_add_f32 v18, v18, v19
    v_mov_b32 v19, 0x207
    v_cmp_class_f32 s[80:81], v18, v19
    v_pk_mul_f32 v[44:45], v[44:45], v[72:73]
    v_pk_mul_f32 v[46:47], v[46:47], v[74:75]
    v_pk_mul_f32 v[48:49], v[48:49], v[76:77]
    v_pk_mul_f32 v[50:51], v[50:51], v[78:79]
    v_pk_mul_f32 v[52:53], v[52:53], v[80:81]
    v_pk_mul_f32 v[54:55], v[54:55], v[82:83]
    v_pk_mul_f32 v[56:57], v[56:57], v[84:85]
    v_pk_mul_f32 v[58:59], v[58:59], v[86:87]
    v_pk_mul_f32 v[60:61], v[60:61], v[88:89]
    v_pk_mul_f32 v[62:63], v[62:63], v[90:91]
    v_pk_mul_f32 v[64:65], v[64:65], v[92:93]
    v_pk_mul_f32 v[66:67], v[66:67], v[94:95]
    v_pk_mul_f32 v[68:69], v[68:69], v[96:97]
    v_pk_mul_f32 v[70:71], v[70:71], v[98:99]
    s_waitcnt vmcnt(0) lgkmcnt(0)
    v_or_b32 v17, v24, v25
    v_or3_b32 v17, v17, v26, v27
    v_cmp_ne_u32 vcc, 0, v17
    s_or_b64 vcc, vcc, s[80:81]
    s_cbranch_scc0 k2_epi
    s_cmp_eq_u64 s[80:81], 0
    s_cbranch_scc1 k2_ovf
    v_mov_b64 v[44:45], 0
    v_mov_b64 v[46:47], 0
    v_mov_b64 v[48:49], 0
    v_mov_b64 v[50:51], 0
    v_mov_b64 v[52:53], 0
    v_mov_b64 v[54:55], 0
    v_mov_b64 v[56:57], 0
    v_mov_b64 v[58:59], 0
    v_mov_b64 v[60:61], 0
    v_mov_b64 v[62:63], 0
    v_mov_b64 v[64:65], 0
    v_mov_b64 v[66:67], 0
    v_mov_b64 v[68:69], 0
    v_mov_b64 v[70:71], 0
    s_add_u32 s57, s76, s7
k2_redo:
    s_cmp_ge_u32 s76, s57
    s_cbranch_scc1 k2_ovf
    s_buffer_load_dword s60, s[40:43], s76
    s_lshr_b32 s58, s76, 1
    v_mov_b32 v12, s58
    ds_read_u16 v12, v12 offset:7168
    s_add_u32 s76, s76, 4
    s_waitcnt lgkmcnt(0)
    s_and_b32 s61, s60, 0xffffff00
    buffer_load_dwordx2 v[28:29], v2, s[44:47], s61 offen sc1
    s_waitcnt lgkmcnt(0)
    v_perm_b32 v8, v12, v12, v10
    v_perm_b32 v9, v12, v12, v11
    s_set_gpr_idx_on s60, gpr_idx(SRC2)
    s_nop 1
    v_mfma_f32_4x4x4_16b_bf16 v[16:19], v[8:9], v[6:7], v[100:103]
    s_set_gpr_idx_off
    s_waitcnt vmcnt(0)
    s_nop 1
    v_mfma_f32_4x4x4_16b_bf16 v[16:19], v[4:5], v[28:29], v[16:19]
    s_nop 7
    v_exp_f32 v20, v16
    v_exp_f32 v21, v17
    v_exp_f32 v22, v18
    v_exp_f32 v23, v19
    s_nop 1
    v_add_f32 v20, 1.0, v20
    v_add_f32 v21, 1.0, v21
    v_add_f32 v22, 1.0, v22
    v_add_f32 v23, 1.0, v23
    v_rcp_f32 v20, v20
    v_rcp_f32 v21, v21
    v_rcp_f32 v22, v22
    v_rcp_f32 v23, v23
    s_set_gpr_idx_on s60, gpr_idx(SRC2,DST)
    v_pk_fma_f32 v[44:45], v[16:17], v[20:21], v[44:45]
    v_pk_fma_f32 v[46:47], v[18:19], v[22:23], v[46:47]
    s_set_gpr_idx_off
    s_branch k2_redo
k2_ovf:
    v_readfirstlane_b32 s48, v24
    v_readfirstlane_b32 s49, v25
    v_readfirstlane_b32 s50, v26
    v_readfirstlane_b32 s51, v27
    s_add_u32 s52, s32, 25165824
    s_addc_u32 s53, s33, 0
    s_mov_b32 s54, 8389632
    s_mov_b32 s55, 0x20000
    s_mov_b32 s56, 0
k2_ov_chunk:
    s_and_b32 s57, s48, 1
    s_lshr_b64 s[48:49], s[48:49], 1
    s_lshl_b32 s58, s50, 31
    s_or_b32 s49, s49, s58
    s_lshr_b64 s[50:51], s[50:51], 1
    s_cmp_eq_u32 s57, 0
    s_cbranch_scc1 k2_ov_next
    s_lshr_b32 s57, s56, 3
    s_lshl_b32 s57, s57, 1
    s_lshr_b32 s58, s2, 7
    s_add_u32 s57, s57, s58
    s_lshl_b32 s57, s57, 3
    s_and_b32 s58, s56, 7
    s_add_u32 s57, s57, s58
    s_lshl_b32 s58, s57, 2
    s_add_u32 s58, s58, 8388608
    s_buffer_load_dword s59, s[52:55], s58
    s_lshl_b32 s57, s57, 15
    s_waitcnt lgkmcnt(0)
    s_min_u32 s59, s59, 25024
    s_add_u32 s59, s59, s57
k2_ov_rec:
    s_cmp_ge_u32 s57, s59
    s_cbranch_scc1 k2_ov_next
    s_buffer_load_dwordx2 s[60:61], s[52:55], s57
    s_add_u32 s57, s57, 8
    s_waitcnt lgkmcnt(0)
    s_and_b32 s58, s60, 0xff
    s_cmp_lg_u32 s58, s2
    s_cbranch_scc1 k2_ov_rec
    s_bfe_u32 s58, s61, 0x70005
    s_lshl_b32 s58, s58, 2
    v_mov_b32 v24, s58
    ds_read_b32 v25, v24 offset:1792
    s_waitcnt lgkmcnt(0)
    v_readfirstlane_b32 s62, v25
    s_lshr_b32 s63, s62, 3
    s_cmp_lg_u32 s63, s3
    s_cbranch_scc1 k2_ov_rec
    v_mov_b32 v25, 1
    s_mov_b64 exec, 1
    ds_add_u32 v24, v25 offset:1280
    s_mov_b64 exec, -1
    s_and_b32 s62, s62, 7
    s_lshl_b32 s62, s62, 2
    s_and_b32 s60, s60, 0xfffffe00
    s_or_b32 s60, s60, s62
    s_lshr_b32 s61, s61, 16
    v_mov_b32 v12, s61
    s_and_b32 s61, s60, 0xffffff00
    buffer_load_dwordx2 v[28:29], v2, s[44:47], s61 offen sc1
    s_waitcnt lgkmcnt(0)
    v_perm_b32 v8, v12, v12, v10
    v_perm_b32 v9, v12, v12, v11
    s_set_gpr_idx_on s60, gpr_idx(SRC2)
    s_nop 1
    v_mfma_f32_4x4x4_16b_bf16 v[16:19], v[8:9], v[6:7], v[100:103]
    s_set_gpr_idx_off
    s_waitcnt vmcnt(0)
    s_nop 1
    v_mfma_f32_4x4x4_16b_bf16 v[16:19], v[4:5], v[28:29], v[16:19]
    s_nop 7
    v_exp_f32 v20, v16
    v_exp_f32 v21, v17
    v_exp_f32 v22, v18
    v_exp_f32 v23, v19
    s_nop 1
    v_add_f32 v20, 1.0, v20
    v_add_f32 v21, 1.0, v21
    v_add_f32 v22, 1.0, v22
    v_add_f32 v23, 1.0, v23
    v_rcp_f32 v20, v20
    v_rcp_f32 v21, v21
    v_rcp_f32 v22, v22
    v_rcp_f32 v23, v23
    s_set_gpr_idx_on s60, gpr_idx(SRC2,DST)
    v_pk_fma_f32 v[44:45], v[16:17], v[20:21], v[44:45]
    v_pk_fma_f32 v[46:47], v[18:19], v[22:23], v[46:47]
    s_set_gpr_idx_off
    s_branch k2_ov_rec
k2_ov_next:
    s_add_u32 s56, s56, 1
    s_cmp_lt_u32 s56, 128
    s_cbranch_scc1 k2_ov_chunk
k2_epi:
    s_and_b32 s5, s3, 3
    s_lshl_b32 s6, s5, 14
    v_add_u32 v15, s6, v3
    v_bfe_u32 v4, v1, 2, 1
    v_lshlrev_b32 v4, 5, v4
    v_bfe_u32 v5, v1, 3, 2
    v_lshl_add_u32 v4, v5, 3, v4
    v_and_b32 v5, 3, v1
    v_lshl_add_u32 v4, v5, 1, v4
    s_lshl_b32 s5, s5, 6
    v_add_u32 v4, s5, v4
    v_mov_b32 v7, 0
    s_mov_b32 exec_hi, 0
    global_load_ushort v7, v4, s[30:31]
    s_mov_b64 exec, -1
    s_mov_b32 s98, 0xbf317218
    s_mov_b32 s99, 0xbf317218
    s_cmp_eq_u32 s10, 127
    s_cbranch_scc1 k2_hsdone
    v_pk_mul_f32 v[44:45], s[98:99], v[44:45]
    v_pk_mul_f32 v[46:47], s[98:99], v[46:47]
    s_mul_i32 s6, s10, 528
    s_add_u32 s6, s6, 81920
    v_cvt_pk_bf16_f32 v44, v44, v45
    v_cvt_pk_bf16_f32 v45, v46, v47
    v_add_u32 v46, s6, v2
    ds_write_b64 v46, v[44:45]
    s_cmp_eq_u32 s11, 127
    s_cbranch_scc1 k2_hsdone
    v_pk_mul_f32 v[48:49], s[98:99], v[48:49]
    v_pk_mul_f32 v[50:51], s[98:99], v[50:51]
    s_mul_i32 s6, s11, 528
    s_add_u32 s6, s6, 81920
    v_cvt_pk_bf16_f32 v48, v48, v49
    v_cvt_pk_bf16_f32 v49, v50, v51
    v_add_u32 v50, s6, v2
    ds_write_b64 v50, v[48:49]
    s_cmp_eq_u32 s12, 127
    s_cbranch_scc1 k2_hsdone
    v_pk_mul_f32 v[52:53], s[98:99], v[52:53]
    v_pk_mul_f32 v[54:55], s[98:99], v[54:55]
    s_mul_i32 s6, s12, 528
    s_add_u32 s6, s6, 81920
    v_cvt_pk_bf16_f32 v52, v52, v53
    v_cvt_pk_bf16_f32 v53, v54, v55
    v_add_u32 v54, s6, v2
    ds_write_b64 v54, v[52:53]
    s_cmp_eq_u32 s13, 127
    s_cbranch_scc1 k2_hsdone
    v_pk_mul_f32 v[56:57], s[98:99], v[56:57]
    v_pk_mul_f32 v[58:59], s[98:99], v[58:59]
    s_mul_i32 s6, s13, 528
    s_add_u32 s6, s6, 81920
    v_cvt_pk_bf16_f32 v56, v56, v57
    v_cvt_pk_bf16_f32 v57, v58, v59
    v_add_u32 v58, s6, v2
    ds_write_b64 v58, v[56:57]
    s_cmp_eq_u32 s14, 127
    s_cbranch_scc1 k2_hsdone
    v_pk_mul_f32 v[60:61], s[98:99], v[60:61]
    v_pk_mul_f32 v[62:63], s[98:99], v[62:63]
    s_mul_i32 s6, s14, 528
    s_add_u32 s6, s6, 81920
    v_cvt_pk_bf16_f32 v60, v60, v61
    v_cvt_pk_bf16_f32 v61, v62, v63
    v_add_u32 v62, s6, v2
    ds_write_b64 v62, v[60:61]
    s_cmp_eq_u32 s15, 127
    s_cbranch_scc1 k2_hsdone
    v_pk_mul_f32 v[64:65], s[98:99], v[64:65]
    v_pk_mul_f32 v[66:67], s[98:99], v[66:67]
    s_mul_i32 s6, s15, 528
    s_add_u32 s6, s6, 81920
    v_cvt_pk_bf16_f32 v64, v64, v65
    v_cvt_pk_bf16_f32 v65, v66, v67
    v_add_u32 v66, s6, v2
    ds_write_b64 v66, v[64:65]
    s_cmp_eq_u32 s96, 127
    s_cbranch_scc1 k2_hsdone
    v_pk_mul_f32 v[68:69], s[98:99], v[68:69]
    v_pk_mul_f32 v[70:71], s[98:99], v[70:71]
    s_mul_i32 s6, s96, 528
    s_add_u32 s6, s6, 81920
    v_cvt_pk_bf16_f32 v68, v68, v69
    v_cvt_pk_bf16_f32 v69, v70, v71
    v_add_u32 v70, s6, v2
    ds_write_b64 v70, v[68:69]
k2_hsdone:
    v_and_b32 v16, 31, v1
    s_lshr_b32 s6, s3, 2
    s_lshl_b32 s6, s6, 5
    v_add_u32 v8, s6, v16
    v_lshrrev_b32 v9, 5, v1
    v_lshlrev_b32 v11, 2, v8
    v_min_u32 v8, 97, v8
    v_mul_u32_u24 v8, 528, v8
    v_lshl_add_u32 v8, v9, 4, v8
    v_add_u32 v8, 81920, v8
    s_lshl_b32 s6, s6, 8
    s_add_u32 s5, s5, s6
    v_lshrrev_b32 v10, 3, v1
    v_xor_b32 v10, v10, v1
    v_and_b32 v10, 3, v10
    v_lshrrev_b32 v17, 2, v1
    v_lshlrev_b32 v17, 8, v17
    v_lshl_add_u32 v10, v10, 4, v17
    v_add_u32 v10, s5, v10
    v_add_u32 v19, 4096, v10
    s_lshl_b32 s6, s3, 11
    s_add_u32 s5, s6, 133664
    s_sub_u32 s6, s6, 20480
    s_cmp_lt_u32 s3, 12
    s_cselect_b32 s5, s5, s6
    v_add_u32 v18, s5, v3
    v_bfe_u32 v17, v1, 1, 2
    v_lshlrev_b32 v9, 1, v9
    v_xor_b32 v17, v17, v9
    v_lshlrev_b32 v17, 4, v17
    v_lshl_add_u32 v16, v16, 6, v17
    v_add_u32 v16, s5, v16
    v_xor_b32 v17, 16, v16
    s_mul_i32 s5, s2, 25088
    s_add_u32 s36, s34, s5
    s_addc_u32 s37, s35, 0
    s_waitcnt lgkmcnt(0)
    s_barrier
    ds_read_b32 v11, v11 offset:1280
    ds_read_b128 v[24:27], v15 offset:16384
    ds_read_b128 v[56:59], v8 offset:0
    ds_read_b128 v[28:31], v15 offset:17408
    ds_read_b128 v[60:63], v8 offset:32
    ds_read_b128 v[32:35], v15 offset:18432
    ds_read_b128 v[64:67], v8 offset:64
    ds_read_b128 v[36:39], v15 offset:19456
    ds_read_b128 v[68:71], v8 offset:96
    ds_read_b128 v[40:43], v15 offset:20480
    ds_read_b128 v[72:75], v8 offset:128
    ds_read_b128 v[44:47], v15 offset:21504
    ds_read_b128 v[76:79], v8 offset:160
    ds_read_b128 v[48:51], v15 offset:22528
    ds_read_b128 v[80:83], v8 offset:192
    s_waitcnt vmcnt(0) lgkmcnt(14)
    v_lshl_or_b32 v6, v7, 16, v7
    v_cvt_f32_ubyte0 v12, v11
    v_and_b32 v13, 0xff00, v11
    v_and_b32 v14, 0xff0000, v11
    v_cvt_f32_u32 v13, v13
    v_cvt_f32_u32 v14, v14
    v_cvt_pk_bf16_f32 v12, v12, v13
    v_lshrrev_b32 v13, 16, v14
    s_nop 1
    v_mfma_f32_32x32x8_bf16 v[88:103], v[6:7], v[12:13], 0
    s_waitcnt lgkmcnt(12)
    v_mfma_f32_32x32x16_bf16 v[88:103], v[24:27], v[56:59], v[88:103]
    ds_read_b128 v[52:55], v15 offset:23552
    ds_read_b128 v[84:87], v8 offset:224
    s_waitcnt lgkmcnt(12)
    v_mfma_f32_32x32x16_bf16 v[88:103], v[28:31], v[60:63], v[88:103]
    ds_read_b128 v[24:27], v15 offset:24576
    ds_read_b128 v[56:59], v8 offset:256
    s_waitcnt lgkmcnt(12)
    v_mfma_f32_32x32x16_bf16 v[88:103], v[32:35], v[64:67], v[88:103]
    ds_read_b128 v[28:31], v15 offset:25600
    ds_read_b128 v[60:63], v8 offset:288
    s_waitcnt lgkmcnt(12)
    v_mfma_f32_32x32x16_bf16 v[88:103], v[36:39], v[68:71], v[88:103]
    ds_read_b128 v[32:35], v15 offset:26624
    ds_read_b128 v[64:67], v8 offset:320
    s_waitcnt lgkmcnt(12)
    v_mfma_f32_32x32x16_bf16 v[88:103], v[40:43], v[72:75], v[88:103]
    ds_read_b128 v[36:39], v15 offset:27648
    ds_read_b128 v[68:71], v8 offset:352
    s_waitcnt lgkmcnt(12)
    v_mfma_f32_32x32x16_bf16 v[88:103], v[44:47], v[76:79], v[88:103]
    ds_read_b128 v[40:43], v15 offset:28672
    ds_read_b128 v[72:75], v8 offset:384
    s_waitcnt lgkmcnt(12)
    v_mfma_f32_32x32x16_bf16 v[88:103], v[48:51], v[80:83], v[88:103]
    ds_read_b128 v[44:47], v15 offset:29696
    ds_read_b128 v[76:79], v8 offset:416
    s_waitcnt lgkmcnt(12)
    v_mfma_f32_32x32x16_bf16 v[88:103], v[52:55], v[84:87], v[88:103]
    ds_read_b128 v[48:51], v15 offset:30720
    ds_read_b128 v[80:83], v8 offset:448
    s_waitcnt lgkmcnt(12)
    v_mfma_f32_32x32x16_bf16 v[88:103], v[24:27], v[56:59], v[88:103]
    ds_read_b128 v[52:55], v15 offset:31744
    ds_read_b128 v[84:87], v8 offset:480
    s_waitcnt lgkmcnt(12)
    v_mfma_f32_32x32x16_bf16 v[88:103], v[28:31], v[60:63], v[88:103]
    s_waitcnt lgkmcnt(10)
    v_mfma_f32_32x32x16_bf16 v[88:103], v[32:35], v[64:67], v[88:103]
    s_waitcnt lgkmcnt(8)
    v_mfma_f32_32x32x16_bf16 v[88:103], v[36:39], v[68:71], v[88:103]
    s_waitcnt lgkmcnt(6)
    v_mfma_f32_32x32x16_bf16 v[88:103], v[40:43], v[72:75], v[88:103]
    s_waitcnt lgkmcnt(4)
    v_mfma_f32_32x32x16_bf16 v[88:103], v[44:47], v[76:79], v[88:103]
    s_waitcnt lgkmcnt(2)
    v_mfma_f32_32x32x16_bf16 v[88:103], v[48:51], v[80:83], v[88:103]
    s_waitcnt lgkmcnt(0)
    v_mfma_f32_32x32x16_bf16 v[88:103], v[52:55], v[84:87], v[88:103]
    s_nop 11
    v_cvt_pk_bf16_f32 v88, v88, v89
    v_cvt_pk_bf16_f32 v89, v90, v91
    v_cvt_pk_bf16_f32 v90, v92, v93
    v_cvt_pk_bf16_f32 v91, v94, v95
    v_cvt_pk_bf16_f32 v92, v96, v97
    v_cvt_pk_bf16_f32 v93, v98, v99
    v_cvt_pk_bf16_f32 v94, v100, v101
    v_cvt_pk_bf16_f32 v95, v102, v103
    ds_write_b128 v16, v[88:91]
    ds_write_b128 v17, v[92:95]
    ds_read_b128 v[96:99], v18
    ds_read_b128 v[100:103], v18 offset:1024
    s_waitcnt lgkmcnt(1)
    buffer_store_dwordx4 v[96:99], v10, s[36:39], 0 offen
    s_waitcnt lgkmcnt(0)
    buffer_store_dwordx4 v[100:103], v19, s[36:39], 0 offen
k2_end:
    s_endpgm
.section .rodata,"a"
.p2align 6
.amdhsa_kernel standalone__edge_featured_mpnn_mpnn__graph_kernel
  .amdhsa_next_free_vgpr 128
  .amdhsa_next_free_sgpr 102
  .amdhsa_accum_offset 128
  .amdhsa_group_segment_fixed_size 0
  .amdhsa_kernarg_size 88
  .amdhsa_user_sgpr_count 2
  .amdhsa_user_sgpr_kernarg_segment_ptr 1
  .amdhsa_system_sgpr_workgroup_id_x 1
.end_amdhsa_kernel
```
